```python
import torch

def _softmax(x, axis=-1):
    return torch.softmax(x, dim=axis)
def _gelu(x):
    return torch.nn.functional.gelu(x, approximate="tanh")
def _silu(x):
    return torch.nn.functional.silu(x)
def _sigmoid(x):
    return torch.sigmoid(x)
def _layernorm(x, axis=-1, eps=1e-5):
    m = x.mean(dim=axis, keepdim=True)
    v = x.var(dim=axis, keepdim=True, unbiased=False)
    return (x - m) / torch.sqrt(v + eps)
def _scatter_add(tgt, idx, src, axis=0):
    return tgt.clone().index_add_(axis, idx, src)
def _segment_sum(src, seg, n):
    out = torch.zeros((n,) + src.shape[1:], dtype=src.dtype)
    return out.index_add_(0, seg, src)
def _pad(x, pw):
    flat = tuple(v for pair in reversed(pw) for v in pair)
    return torch.nn.functional.pad(x, flat)

kernel_name = 'gated_mix__grouped_kv_mqa__grouped_kv_mqa__prompt'

def setup_inputs():

    _w = (lambda a: (lambda t: t.to(torch.bfloat16) if t.is_floating_point() else t)(torch.as_tensor(a)))
    def _A_setup():
        B, S, D, H = 1, 2048, 448, 16
        Dh = D // H
        return {
            "x": _w((lambda *s: torch.randn(*s, dtype=torch.bfloat16) * 0.05)(B, S, D)),
            "wq": _w((lambda *s: torch.randn(*s, dtype=torch.bfloat16) * 0.8)(D, H * Dh)),
            "wk": _w((lambda *s: torch.randn(*s, dtype=torch.bfloat16) * 0.8)(D, Dh)),
            "wv": _w((lambda *s: torch.randn(*s, dtype=torch.bfloat16) * 0.05)(D, Dh)),
            "wo": _w((lambda *s: torch.randn(*s, dtype=torch.bfloat16) * 0.05)(H * Dh, D)),
        }
    _A_in = _A_setup()

    def _B_setup():
        B, S, D, H = 1, 2048, 448, 16
        Dh = D // H
        return {
            "x": _w((lambda *s: torch.randn(*s, dtype=torch.bfloat16) * 0.05)(B, S, D)),
            "wq": _w((lambda *s: torch.randn(*s, dtype=torch.bfloat16) * 0.8)(D, H * Dh)),
            "wk": _w((lambda *s: torch.randn(*s, dtype=torch.bfloat16) * 0.8)(D, Dh)),
            "wv": _w((lambda *s: torch.randn(*s, dtype=torch.bfloat16) * 0.05)(D, Dh)),
            "wo": _w((lambda *s: torch.randn(*s, dtype=torch.bfloat16) * 0.05)(H * Dh, D)),
        }
    _B_in = _B_setup()

    return {
        "A_x": _A_in["x"],
        "A_wq": _A_in["wq"],
        "A_wk": _A_in["wk"],
        "A_wv": _A_in["wv"],
        "A_wo": _A_in["wo"],
        "B_x": _B_in["x"],
        "B_wq": _B_in["wq"],
        "B_wk": _B_in["wk"],
        "B_wv": _B_in["wv"],
        "B_wo": _B_in["wo"],
        "gate_w": _w((lambda *s: torch.randn(*s, dtype=torch.bfloat16) * 0.05)(448) * 16.0),
    }

def reference(A_x, A_wq, A_wk, A_wv, A_wo, B_x, B_wq, B_wk, B_wv, B_wo, gate_w):
    def _A_ref(x, wq, wk, wv, wo):
        B, S, D = x.shape
        H = 16
        Dh = D // H
        q = (lambda x, *d: x.permute(*d))((x @ wq).reshape(B, S, H, Dh), 0, 2, 1, 3)
        k = x @ wk
        v = x @ wv
        scores = torch.einsum("bhqd,bkd->bhqk", q, k) * (Dh ** -0.5)
        p = _softmax(scores, axis=-1)
        o = torch.einsum("bhqk,bkd->bhqd", p, v)
        return (lambda x, *d: x.permute(*d))(o, 0, 2, 1, 3).reshape(B, S, H * Dh) @ wo

    def _B_ref(x, wq, wk, wv, wo):
        B, S, D = x.shape
        H = 16
        Dh = D // H
        q = (lambda x, *d: x.permute(*d))((x @ wq).reshape(B, S, H, Dh), 0, 2, 1, 3)
        k = x @ wk
        v = x @ wv
        scores = torch.einsum("bhqd,bkd->bhqk", q, k) * (Dh ** -0.5)
        p = _softmax(scores, axis=-1)
        o = torch.einsum("bhqk,bkd->bhqd", p, v)
        return (lambda x, *d: x.permute(*d))(o, 0, 2, 1, 3).reshape(B, S, H * Dh) @ wo

    x = A_x
    g = _sigmoid((x * gate_w).sum(-1, keepdims=True))
    a = _A_ref(x, A_wq, A_wk, A_wv, A_wo)
    b = _B_ref(x, B_wq, B_wk, B_wv, B_wo)
    return g * a + (1 - g) * b
```

```asm
; @launch grid=(256,1,1) block=(512,1,1) lds=163840
.amdgcn_target "amdgcn-amd-amdhsa--gfx950"
.text
.p2align 12
.fill 832, 4, 0xbf800000
.globl gated_mix__grouped_kv_mqa__grouped_kv_mqa__prompt_kernel
.p2align 8
.type gated_mix__grouped_kv_mqa__grouped_kv_mqa__prompt_kernel,@function
gated_mix__grouped_kv_mqa__grouped_kv_mqa__prompt_kernel:
    s_cmp_ge_u32 s2, 256
    s_cbranch_scc1 k_end
    s_bfe_u32 s41, s2, 0x10003
    s_mul_i32 s3, s41, 40
    s_load_dwordx2 s[16:17], s[0:1], 0
    s_bfe_u32 s43, s2, 0x20004
    s_lshr_b32 s52, s43, 1
    s_lshl_b32 s51, s52, 3
    s_add_u32 s51, s51, s3
    s_add_u32 s51, s51, 16
    s_load_dwordx2 s[88:89], s[0:1], s51
    s_load_dwordx2 s[92:93], s[0:1], 80
    s_add_u32 s3, s3, 8
    s_load_dwordx2 s[6:7], s[0:1], s3
    s_load_dwordx2 s[14:15], s[0:1], 104
    s_load_dwordx2 s[8:9], s[0:1], 32
    s_load_dwordx2 s[10:11], s[0:1], 72
    s_load_dwordx2 s[12:13], s[0:1], 88
    v_lshrrev_b32 v1, 6, v0
    v_and_b32 v0, 63, v0
    v_readfirstlane_b32 s40, v1
    s_and_b32 s3, s2, 7
    s_lshl_b32 s3, s3, 2
    s_lshr_b32 s42, s2, 6
    s_lshl_b32 s52, s52, 1
    s_add_u32 s52, s52, s41
    s_add_u32 s52, s52, s42
    s_lshl_b32 s52, s52, 1
    s_add_u32 s42, s42, s3
    s_and_b32 s61, s43, 1
    s_add_u32 s52, s52, s61
    s_cmp_ge_u32 s52, 7
    s_cselect_b32 s3, 7, 0
    s_sub_u32 s85, s52, s3
    v_lshlrev_b32 v1, 4, v0
    v_lshrrev_b32 v3, 4, v0
    v_and_b32 v4, 7, v0
    v_xor_b32 v3, v3, v4
    v_lshlrev_b32 v3, 4, v3
    v_lshrrev_b32 v4, 3, v0
    v_mul_u32_u24 v4, 896, v4
    v_add_u32 v104, v3, v4
    s_mul_i32 s60, s42, 57344
    s_mov_b32 s18, 1835008
    s_mov_b32 s19, 0x20000
    s_cmp_eq_u32 s40, 0
    s_cbranch_scc1 k_crit
    s_cmp_ge_u32 s40, 4
    s_cbranch_scc1 k_loader
    s_cmp_eq_u32 s40, 1
    s_cbranch_scc1 k_pv0
    s_cmp_eq_u32 s40, 2
    s_cbranch_scc1 k_pv1
    s_cmp_eq_u32 s40, 3
    s_cbranch_scc1 k_pv2
k_b0:
    s_waitcnt lgkmcnt(0)
    s_barrier
    s_cmp_eq_u32 s40, 1
    s_cbranch_scc1 k_pv3
    s_cmp_eq_u32 s40, 2
    s_cbranch_scc1 k_pv4
    s_cmp_eq_u32 s40, 3
    s_cbranch_scc1 k_pv5
    s_branch k_setup
k_crit:
    s_setprio 3
    v_xor_b32 v105, 64, v104
    s_mul_i32 s51, s61, 28672
    s_add_u32 s60, s60, s51
    v_add_u32 v106, 12288, v104
    v_add_u32 v107, 18432, v105
    v_add_u32 v105, 6144, v105
    s_lshl_b32 s84, s85, 7
    v_add_u32 v116, s84, v1
    v_subrev_u32 v117, 896, v116
    v_min_u32 v116, v116, v117
    s_add_u32 s84, s84, s60
    s_mul_i32 s85, s85, 3584
    s_lshl_b32 s59, s61, 12
    s_add_u32 s59, s59, 71936
    s_mov_b32 s90, 25088
    s_mov_b32 s91, 0x20000
    s_mov_b32 s94, 896
    s_mov_b32 s95, 0x20000
    s_lshl_b32 s3, s41, 2
    s_add_u32 s3, s3, s43
    s_mov_b32 m0, 158208
    s_cmp_lt_u32 s3, 2
    s_waitcnt lgkmcnt(0)
    s_cbranch_scc0 k_nogl
    s_mov_b32 exec_hi, 0xffffff
    buffer_load_dwordx4 v116, s[92:95], 0 offen lds
    s_mov_b32 exec_hi, -1
k_nogl:
    s_mov_b32 s86, 129280
    s_mov_b32 s87, s59
k_cl:
    s_mov_b32 m0, s86
    s_add_u32 s86, s86, 3584
    buffer_load_dwordx4 v1, s[88:91], s85 offen lds
    buffer_load_dwordx4 v1, s[88:91], s85 offen offset:1024 lds
    buffer_load_dwordx4 v1, s[88:91], s85 offen offset:2048 lds
    s_mov_b32 exec_hi, 0
    buffer_load_dwordx4 v1, s[88:91], s85 offen offset:3072 lds
    s_mov_b32 m0, s87
    s_mov_b32 exec_hi, -1
    buffer_load_dwordx4 v104, s[16:19], s84 offen lds
    buffer_load_dwordx4 v105, s[16:19], s84 offen offset:1024 lds
    buffer_load_dwordx4 v106, s[16:19], s84 offen offset:2048 lds
    buffer_load_dwordx4 v107, s[16:19], s84 offen offset:3072 lds
    s_add_u32 s87, s87, 8192
    s_add_u32 s84, s84, 128
    s_add_u32 s85, s85, 3584
    s_cmp_eq_u32 s85, 25088
    s_cselect_b32 s85, 0, s85
    s_cselect_b32 s84, s60, s84
    s_cmp_eq_u32 s86, 140032
    s_cbranch_scc0 k_clr
    v_lshrrev_b32 v3, 5, v0
    v_and_b32 v116, 31, v0
    v_bfe_u32 v117, v0, 1, 3
    v_xor_b32 v117, v117, v3
    v_lshlrev_b32 v117, 4, v117
    v_lshl_add_u32 v121, v116, 7, v117
    v_bfe_u32 v4, v0, 4, 1
    v_lshlrev_b32 v4, 5, v4
    v_and_b32 v116, 3, v0
    v_lshl_add_u32 v4, v116, 3, v4
    v_bfe_u32 v116, v0, 2, 2
    v_lshl_add_u32 v120, v3, 3, v116
    v_mul_u32_u24 v120, 56, v120
    v_add_u32 v120, v120, v4
    v_add_u32 v120, 129280, v120
    v_lshlrev_b32 v125, 4, v3
    v_add_u32 v125, 158208, v125
    v_add_u32 v121, s59, v121
    v_xor_b32 v122, 32, v121
    v_xor_b32 v123, 64, v121
    v_xor_b32 v124, 96, v121
    v_and_b32 v3, 31, v0
    v_mov_b32 v116, 0x3f803f80
    v_cmp_eq_u32 vcc, 28, v3
    v_mov_b32 v126, 0
    v_lshlrev_b32 v3, 2, v3
    v_cndmask_b32 v126, v126, v116, vcc
    s_lshl_b32 s3, s42, 1
    s_add_u32 s3, s3, s61
    s_lshl_b32 s83, s3, 7
    s_add_u32 s83, s83, 524288
    s_lshl_b32 s3, s3, 12
    s_lshl_b32 s51, s41, 18
    s_add_u32 s3, s3, s51
    s_lshr_b32 s51, s43, 1
    s_lshl_b32 s51, s51, 11
    s_add_u32 s82, s3, s51
k_clr:
    s_cmp_lt_u32 s86, 154368
    s_cbranch_scc1 k_cl
    s_mov_b32 s32, s14
    s_mov_b32 s33, s15
    s_mov_b32 s34, 5242880
    s_mov_b32 s35, 0x20000
    v_mov_b32 v116, 0
    s_mov_b32 s3, 536576
    buffer_load_dwordx2 v[118:119], v116, s[32:35], s3 offen sc1
    s_barrier
k_kv:
    s_cmp_lt_u32 s43, 2
    s_cbranch_scc0 k_kvv
    s_waitcnt vmcnt(49)
    ds_read_b64_tr_b16 v[128:129], v120
    ds_read_b64_tr_b16 v[130:131], v120 offset:224
    ds_read_b128 v[144:147], v121
    ds_read_b64_tr_b16 v[132:133], v120 offset:896
    ds_read_b64_tr_b16 v[134:135], v120 offset:1120
    ds_read_b128 v[148:151], v122
    ds_read_b64_tr_b16 v[136:137], v120 offset:1792
    ds_read_b64_tr_b16 v[138:139], v120 offset:2016
    ds_read_b128 v[152:155], v123
    ds_read_b64_tr_b16 v[140:141], v120 offset:2688
    ds_read_b64_tr_b16 v[142:143], v120 offset:2912
    ds_read_b128 v[156:159], v124
    s_mov_b32 exec_lo, 0x10000000
    s_mov_b32 exec_hi, 0x10000000
    ds_read_b128 v[128:131], v125
    ds_read_b128 v[132:135], v125 offset:32
    ds_read_b128 v[136:139], v125 offset:64
    ds_read_b128 v[140:143], v125 offset:96
    s_mov_b64 exec, -1
    s_waitcnt lgkmcnt(0)
    v_mfma_f32_32x32x16_bf16 v[16:31], v[128:131], v[144:147], 0
    s_waitcnt vmcnt(41)
    ds_read_b64_tr_b16 v[160:161], v120 offset:3584
    ds_read_b64_tr_b16 v[162:163], v120 offset:3808
    ds_read_b128 v[176:179], v121 offset:8192
    s_branch k_pv0_over
k_pv0:
    s_branch k_b0
k_pv0_over:
    v_mfma_f32_32x32x16_bf16 v[16:31], v[132:135], v[148:151], v[16:31]
    ds_read_b64_tr_b16 v[164:165], v120 offset:4480
    ds_read_b64_tr_b16 v[166:167], v120 offset:4704
    ds_read_b128 v[180:183], v122 offset:8192
    v_mfma_f32_32x32x16_bf16 v[16:31], v[136:139], v[152:155], v[16:31]
    ds_read_b64_tr_b16 v[168:169], v120 offset:5376
    ds_read_b64_tr_b16 v[170:171], v120 offset:5600
    ds_read_b128 v[184:187], v123 offset:8192
    v_mfma_f32_32x32x16_bf16 v[16:31], v[140:143], v[156:159], v[16:31]
    ds_read_b64_tr_b16 v[172:173], v120 offset:6272
    ds_read_b64_tr_b16 v[174:175], v120 offset:6496
    ds_read_b128 v[188:191], v124 offset:8192
    s_mov_b32 exec_lo, 0x10000000
    s_mov_b32 exec_hi, 0x10000000
    ds_read_b128 v[160:163], v125 offset:128
    ds_read_b128 v[164:167], v125 offset:160
    ds_read_b128 v[168:171], v125 offset:192
    ds_read_b128 v[172:175], v125 offset:224
    s_mov_b64 exec, -1
    s_waitcnt lgkmcnt(0)
    v_mfma_f32_32x32x16_bf16 v[16:31], v[160:163], v[176:179], v[16:31]
    s_waitcnt vmcnt(33)
    ds_read_b64_tr_b16 v[128:129], v120 offset:7168
    ds_read_b64_tr_b16 v[130:131], v120 offset:7392
    ds_read_b128 v[144:147], v121 offset:16384
    v_mfma_f32_32x32x16_bf16 v[16:31], v[164:167], v[180:183], v[16:31]
    ds_read_b64_tr_b16 v[132:133], v120 offset:8064
    ds_read_b64_tr_b16 v[134:135], v120 offset:8288
    ds_read_b128 v[148:151], v122 offset:16384
    v_mfma_f32_32x32x16_bf16 v[16:31], v[168:171], v[184:187], v[16:31]
    ds_read_b64_tr_b16 v[136:137], v120 offset:8960
    ds_read_b64_tr_b16 v[138:139], v120 offset:9184
    ds_read_b128 v[152:155], v123 offset:16384
    v_mfma_f32_32x32x16_bf16 v[16:31], v[172:175], v[188:191], v[16:31]
    ds_read_b64_tr_b16 v[140:141], v120 offset:9856
    ds_read_b64_tr_b16 v[142:143], v120 offset:10080
    ds_read_b128 v[156:159], v124 offset:16384
    s_mov_b32 exec_lo, 0x10000000
    s_mov_b32 exec_hi, 0x10000000
    ds_read_b128 v[128:131], v125 offset:256
    ds_read_b128 v[132:135], v125 offset:288
    ds_read_b128 v[136:139], v125 offset:320
    ds_read_b128 v[140:143], v125 offset:352
    s_mov_b64 exec, -1
    s_waitcnt lgkmcnt(0)
    v_mfma_f32_32x32x16_bf16 v[16:31], v[128:131], v[144:147], v[16:31]
    s_waitcnt vmcnt(25)
    ds_read_b64_tr_b16 v[160:161], v120 offset:10752
    ds_read_b64_tr_b16 v[162:163], v120 offset:10976
    ds_read_b128 v[176:179], v121 offset:24576
    v_mfma_f32_32x32x16_bf16 v[16:31], v[132:135], v[148:151], v[16:31]
    ds_read_b64_tr_b16 v[164:165], v120 offset:11648
    ds_read_b64_tr_b16 v[166:167], v120 offset:11872
    ds_read_b128 v[180:183], v122 offset:24576
    v_mfma_f32_32x32x16_bf16 v[16:31], v[136:139], v[152:155], v[16:31]
    ds_read_b64_tr_b16 v[168:169], v120 offset:12544
    ds_read_b64_tr_b16 v[170:171], v120 offset:12768
    ds_read_b128 v[184:187], v123 offset:24576
    v_mfma_f32_32x32x16_bf16 v[16:31], v[140:143], v[156:159], v[16:31]
    ds_read_b64_tr_b16 v[172:173], v120 offset:13440
    ds_read_b64_tr_b16 v[174:175], v120 offset:13664
    ds_read_b128 v[188:191], v124 offset:24576
    s_mov_b32 exec_lo, 0x10000000
    s_mov_b32 exec_hi, 0x10000000
    ds_read_b128 v[160:163], v125 offset:384
    ds_read_b128 v[164:167], v125 offset:416
    ds_read_b128 v[168:171], v125 offset:448
    ds_read_b128 v[172:175], v125 offset:480
    s_mov_b64 exec, -1
    s_waitcnt lgkmcnt(0)
    v_mfma_f32_32x32x16_bf16 v[16:31], v[160:163], v[176:179], v[16:31]
    s_waitcnt vmcnt(17)
    ds_read_b64_tr_b16 v[128:129], v120 offset:14336
    ds_read_b64_tr_b16 v[130:131], v120 offset:14560
    ds_read_b128 v[144:147], v121 offset:32768
    v_mfma_f32_32x32x16_bf16 v[16:31], v[164:167], v[180:183], v[16:31]
    ds_read_b64_tr_b16 v[132:133], v120 offset:15232
    ds_read_b64_tr_b16 v[134:135], v120 offset:15456
    ds_read_b128 v[148:151], v122 offset:32768
    v_mfma_f32_32x32x16_bf16 v[16:31], v[168:171], v[184:187], v[16:31]
    ds_read_b64_tr_b16 v[136:137], v120 offset:16128
    ds_read_b64_tr_b16 v[138:139], v120 offset:16352
    ds_read_b128 v[152:155], v123 offset:32768
    v_mfma_f32_32x32x16_bf16 v[16:31], v[172:175], v[188:191], v[16:31]
    ds_read_b64_tr_b16 v[140:141], v120 offset:17024
    ds_read_b64_tr_b16 v[142:143], v120 offset:17248
    ds_read_b128 v[156:159], v124 offset:32768
    s_mov_b32 exec_lo, 0x10000000
    s_mov_b32 exec_hi, 0x10000000
    ds_read_b128 v[128:131], v125 offset:512
    ds_read_b128 v[132:135], v125 offset:544
    ds_read_b128 v[136:139], v125 offset:576
    ds_read_b128 v[140:143], v125 offset:608
    s_mov_b64 exec, -1
    s_waitcnt lgkmcnt(0)
    v_mfma_f32_32x32x16_bf16 v[16:31], v[128:131], v[144:147], v[16:31]
    s_waitcnt vmcnt(9)
    ds_read_b64_tr_b16 v[160:161], v120 offset:17920
    ds_read_b64_tr_b16 v[162:163], v120 offset:18144
    ds_read_b128 v[176:179], v121 offset:40960
    v_mfma_f32_32x32x16_bf16 v[16:31], v[132:135], v[148:151], v[16:31]
    ds_read_b64_tr_b16 v[164:165], v120 offset:18816
    ds_read_b64_tr_b16 v[166:167], v120 offset:19040
    ds_read_b128 v[180:183], v122 offset:40960
    v_mfma_f32_32x32x16_bf16 v[16:31], v[136:139], v[152:155], v[16:31]
    ds_read_b64_tr_b16 v[168:169], v120 offset:19712
    ds_read_b64_tr_b16 v[170:171], v120 offset:19936
    ds_read_b128 v[184:187], v123 offset:40960
    v_mfma_f32_32x32x16_bf16 v[16:31], v[140:143], v[156:159], v[16:31]
    ds_read_b64_tr_b16 v[172:173], v120 offset:20608
    ds_read_b64_tr_b16 v[174:175], v120 offset:20832
    ds_read_b128 v[188:191], v124 offset:40960
    s_mov_b32 exec_lo, 0x10000000
    s_mov_b32 exec_hi, 0x10000000
    ds_read_b128 v[160:163], v125 offset:640
    ds_read_b128 v[164:167], v125 offset:672
    ds_read_b128 v[168:171], v125 offset:704
    ds_read_b128 v[172:175], v125 offset:736
    s_mov_b64 exec, -1
    s_waitcnt lgkmcnt(0)
    v_mfma_f32_32x32x16_bf16 v[16:31], v[160:163], v[176:179], v[16:31]
    s_waitcnt vmcnt(1)
    ds_read_b64_tr_b16 v[128:129], v120 offset:21504
    ds_read_b64_tr_b16 v[130:131], v120 offset:21728
    ds_read_b128 v[144:147], v121 offset:49152
    v_mfma_f32_32x32x16_bf16 v[16:31], v[164:167], v[180:183], v[16:31]
    ds_read_b64_tr_b16 v[132:133], v120 offset:22400
    ds_read_b64_tr_b16 v[134:135], v120 offset:22624
    ds_read_b128 v[148:151], v122 offset:49152
    v_mfma_f32_32x32x16_bf16 v[16:31], v[168:171], v[184:187], v[16:31]
    ds_read_b64_tr_b16 v[136:137], v120 offset:23296
    ds_read_b64_tr_b16 v[138:139], v120 offset:23520
    ds_read_b128 v[152:155], v123 offset:49152
    v_mfma_f32_32x32x16_bf16 v[16:31], v[172:175], v[188:191], v[16:31]
    ds_read_b64_tr_b16 v[140:141], v120 offset:24192
    ds_read_b64_tr_b16 v[142:143], v120 offset:24416
    ds_read_b128 v[156:159], v124 offset:49152
    s_mov_b32 exec_lo, 0x10000000
    s_mov_b32 exec_hi, 0x10000000
    ds_read_b128 v[128:131], v125 offset:768
    ds_read_b128 v[132:135], v125 offset:800
    ds_read_b128 v[136:139], v125 offset:832
    s_branch k_pv1_over
k_pv1:
    s_branch k_b0
k_pv1_over:
    ds_read_b128 v[140:143], v125 offset:864
    s_mov_b64 exec, -1
    s_waitcnt lgkmcnt(0)
    v_mfma_f32_32x32x16_bf16 v[16:31], v[128:131], v[144:147], v[16:31]
    v_mfma_f32_32x32x16_bf16 v[16:31], v[132:135], v[148:151], v[16:31]
    v_mfma_f32_32x32x16_bf16 v[16:31], v[136:139], v[152:155], v[16:31]
    v_mfma_f32_32x32x16_bf16 v[16:31], v[140:143], v[156:159], v[16:31]
    s_nop 7
    s_nop 3
    v_cvt_pk_bf16_f32 v48, v16, v17
    v_cvt_pk_bf16_f32 v49, v18, v19
    v_cvt_pk_bf16_f32 v50, v20, v21
    v_cvt_pk_bf16_f32 v51, v22, v23
    v_cvt_pk_bf16_f32 v52, v24, v25
    v_cvt_pk_bf16_f32 v53, v26, v27
    v_cvt_pk_bf16_f32 v54, v28, v29
    v_cvt_pk_bf16_f32 v55, v30, v31
    s_mov_b32 exec_lo, 0
    v_mov_b32 v54, 0
    v_mov_b32 v55, 0
    s_mov_b32 exec_lo, -1
    s_branch k_kvst
k_kvv:
    s_waitcnt vmcnt(49)
    ds_read_b64_tr_b16 v[128:129], v120
    ds_read_b64_tr_b16 v[130:131], v120 offset:224
    ds_read_b128 v[144:147], v121
    ds_read_b64_tr_b16 v[132:133], v120 offset:896
    ds_read_b64_tr_b16 v[134:135], v120 offset:1120
    ds_read_b128 v[148:151], v122
    ds_read_b64_tr_b16 v[136:137], v120 offset:1792
    ds_read_b64_tr_b16 v[138:139], v120 offset:2016
    ds_read_b128 v[152:155], v123
    ds_read_b64_tr_b16 v[140:141], v120 offset:2688
    ds_read_b64_tr_b16 v[142:143], v120 offset:2912
    ds_read_b128 v[156:159], v124
    s_waitcnt lgkmcnt(0)
    v_mfma_f32_32x32x16_bf16 v[16:31], v[144:147], v[128:131], 0
    s_waitcnt vmcnt(41)
    ds_read_b64_tr_b16 v[160:161], v120 offset:3584
    ds_read_b64_tr_b16 v[162:163], v120 offset:3808
    ds_read_b128 v[176:179], v121 offset:8192
    v_mfma_f32_32x32x16_bf16 v[16:31], v[148:151], v[132:135], v[16:31]
    ds_read_b64_tr_b16 v[164:165], v120 offset:4480
    ds_read_b64_tr_b16 v[166:167], v120 offset:4704
    ds_read_b128 v[180:183], v122 offset:8192
    v_mfma_f32_32x32x16_bf16 v[16:31], v[152:155], v[136:139], v[16:31]
    ds_read_b64_tr_b16 v[168:169], v120 offset:5376
    ds_read_b64_tr_b16 v[170:171], v120 offset:5600
    ds_read_b128 v[184:187], v123 offset:8192
    v_mfma_f32_32x32x16_bf16 v[16:31], v[156:159], v[140:143], v[16:31]
    ds_read_b64_tr_b16 v[172:173], v120 offset:6272
    ds_read_b64_tr_b16 v[174:175], v120 offset:6496
    ds_read_b128 v[188:191], v124 offset:8192
    s_waitcnt lgkmcnt(0)
    v_mfma_f32_32x32x16_bf16 v[16:31], v[176:179], v[160:163], v[16:31]
    s_waitcnt vmcnt(33)
    ds_read_b64_tr_b16 v[128:129], v120 offset:7168
    ds_read_b64_tr_b16 v[130:131], v120 offset:7392
    ds_read_b128 v[144:147], v121 offset:16384
    v_mfma_f32_32x32x16_bf16 v[16:31], v[180:183], v[164:167], v[16:31]
    ds_read_b64_tr_b16 v[132:133], v120 offset:8064
    ds_read_b64_tr_b16 v[134:135], v120 offset:8288
    ds_read_b128 v[148:151], v122 offset:16384
    v_mfma_f32_32x32x16_bf16 v[16:31], v[184:187], v[168:171], v[16:31]
    ds_read_b64_tr_b16 v[136:137], v120 offset:8960
    ds_read_b64_tr_b16 v[138:139], v120 offset:9184
    ds_read_b128 v[152:155], v123 offset:16384
    v_mfma_f32_32x32x16_bf16 v[16:31], v[188:191], v[172:175], v[16:31]
    ds_read_b64_tr_b16 v[140:141], v120 offset:9856
    ds_read_b64_tr_b16 v[142:143], v120 offset:10080
    ds_read_b128 v[156:159], v124 offset:16384
    s_waitcnt lgkmcnt(0)
    v_mfma_f32_32x32x16_bf16 v[16:31], v[144:147], v[128:131], v[16:31]
    s_waitcnt vmcnt(25)
    ds_read_b64_tr_b16 v[160:161], v120 offset:10752
    ds_read_b64_tr_b16 v[162:163], v120 offset:10976
    ds_read_b128 v[176:179], v121 offset:24576
    v_mfma_f32_32x32x16_bf16 v[16:31], v[148:151], v[132:135], v[16:31]
    ds_read_b64_tr_b16 v[164:165], v120 offset:11648
    ds_read_b64_tr_b16 v[166:167], v120 offset:11872
    ds_read_b128 v[180:183], v122 offset:24576
    v_mfma_f32_32x32x16_bf16 v[16:31], v[152:155], v[136:139], v[16:31]
    ds_read_b64_tr_b16 v[168:169], v120 offset:12544
    ds_read_b64_tr_b16 v[170:171], v120 offset:12768
    ds_read_b128 v[184:187], v123 offset:24576
    v_mfma_f32_32x32x16_bf16 v[16:31], v[156:159], v[140:143], v[16:31]
    ds_read_b64_tr_b16 v[172:173], v120 offset:13440
    ds_read_b64_tr_b16 v[174:175], v120 offset:13664
    ds_read_b128 v[188:191], v124 offset:24576
    s_waitcnt lgkmcnt(0)
    v_mfma_f32_32x32x16_bf16 v[16:31], v[176:179], v[160:163], v[16:31]
    s_waitcnt vmcnt(17)
    ds_read_b64_tr_b16 v[128:129], v120 offset:14336
    ds_read_b64_tr_b16 v[130:131], v120 offset:14560
    ds_read_b128 v[144:147], v121 offset:32768
    v_mfma_f32_32x32x16_bf16 v[16:31], v[180:183], v[164:167], v[16:31]
    ds_read_b64_tr_b16 v[132:133], v120 offset:15232
    ds_read_b64_tr_b16 v[134:135], v120 offset:15456
    ds_read_b128 v[148:151], v122 offset:32768
    v_mfma_f32_32x32x16_bf16 v[16:31], v[184:187], v[168:171], v[16:31]
    ds_read_b64_tr_b16 v[136:137], v120 offset:16128
    ds_read_b64_tr_b16 v[138:139], v120 offset:16352
    ds_read_b128 v[152:155], v123 offset:32768
    v_mfma_f32_32x32x16_bf16 v[16:31], v[188:191], v[172:175], v[16:31]
    ds_read_b64_tr_b16 v[140:141], v120 offset:17024
    ds_read_b64_tr_b16 v[142:143], v120 offset:17248
    ds_read_b128 v[156:159], v124 offset:32768
    s_waitcnt lgkmcnt(0)
    v_mfma_f32_32x32x16_bf16 v[16:31], v[144:147], v[128:131], v[16:31]
    s_waitcnt vmcnt(9)
    ds_read_b64_tr_b16 v[160:161], v120 offset:17920
    ds_read_b64_tr_b16 v[162:163], v120 offset:18144
    ds_read_b128 v[176:179], v121 offset:40960
    v_mfma_f32_32x32x16_bf16 v[16:31], v[148:151], v[132:135], v[16:31]
    ds_read_b64_tr_b16 v[164:165], v120 offset:18816
    ds_read_b64_tr_b16 v[166:167], v120 offset:19040
    ds_read_b128 v[180:183], v122 offset:40960
    v_mfma_f32_32x32x16_bf16 v[16:31], v[152:155], v[136:139], v[16:31]
    ds_read_b64_tr_b16 v[168:169], v120 offset:19712
    ds_read_b64_tr_b16 v[170:171], v120 offset:19936
    ds_read_b128 v[184:187], v123 offset:40960
    v_mfma_f32_32x32x16_bf16 v[16:31], v[156:159], v[140:143], v[16:31]
    ds_read_b64_tr_b16 v[172:173], v120 offset:20608
    ds_read_b64_tr_b16 v[174:175], v120 offset:20832
    ds_read_b128 v[188:191], v124 offset:40960
    s_waitcnt lgkmcnt(0)
    v_mfma_f32_32x32x16_bf16 v[16:31], v[176:179], v[160:163], v[16:31]
    s_waitcnt vmcnt(1)
    ds_read_b64_tr_b16 v[128:129], v120 offset:21504
    ds_read_b64_tr_b16 v[130:131], v120 offset:21728
    ds_read_b128 v[144:147], v121 offset:49152
    v_mfma_f32_32x32x16_bf16 v[16:31], v[180:183], v[164:167], v[16:31]
    ds_read_b64_tr_b16 v[132:133], v120 offset:22400
    ds_read_b64_tr_b16 v[134:135], v120 offset:22624
    ds_read_b128 v[148:151], v122 offset:49152
    v_mfma_f32_32x32x16_bf16 v[16:31], v[184:187], v[168:171], v[16:31]
    ds_read_b64_tr_b16 v[136:137], v120 offset:23296
    ds_read_b64_tr_b16 v[138:139], v120 offset:23520
    ds_read_b128 v[152:155], v123 offset:49152
    v_mfma_f32_32x32x16_bf16 v[16:31], v[188:191], v[172:175], v[16:31]
    ds_read_b64_tr_b16 v[140:141], v120 offset:24192
    ds_read_b64_tr_b16 v[142:143], v120 offset:24416
    ds_read_b128 v[156:159], v124 offset:49152
    s_waitcnt lgkmcnt(0)
    v_mfma_f32_32x32x16_bf16 v[16:31], v[144:147], v[128:131], v[16:31]
    v_mfma_f32_32x32x16_bf16 v[16:31], v[148:151], v[132:135], v[16:31]
    v_mfma_f32_32x32x16_bf16 v[16:31], v[152:155], v[136:139], v[16:31]
    v_mfma_f32_32x32x16_bf16 v[16:31], v[156:159], v[140:143], v[16:31]
    s_nop 7
    s_nop 3
    v_cvt_pk_bf16_f32 v48, v16, v17
    v_cvt_pk_bf16_f32 v49, v18, v19
    v_cvt_pk_bf16_f32 v50, v20, v21
    v_cvt_pk_bf16_f32 v51, v22, v23
    v_cvt_pk_bf16_f32 v52, v24, v25
    v_cvt_pk_bf16_f32 v53, v26, v27
    s_branch k_pv2_over
k_pv2:
    s_branch k_b0
k_pv2_over:
    v_cvt_pk_bf16_f32 v54, v28, v29
    v_cvt_pk_bf16_f32 v55, v30, v31
    s_mov_b32 exec_lo, 0xf0000000
    s_mov_b32 exec_hi, 0xf0000000
    v_mov_b32 v48, v126
    v_mov_b32 v49, v126
    v_mov_b32 v50, v126
    v_mov_b32 v51, v126
    v_mov_b32 v52, v126
    v_mov_b32 v53, v126
    v_mov_b32 v54, v126
    v_mov_b32 v55, v126
    s_mov_b64 exec, -1
k_kvst:
    buffer_store_dwordx4 v[48:51], v1, s[32:35], s82 offen sc1
    buffer_store_dwordx4 v[52:55], v1, s[32:35], s82 offen offset:1024 sc1
    s_lshl_b32 s3, s41, 2
    s_add_u32 s3, s3, s43
    s_cmp_lt_u32 s3, 2
    s_cbranch_scc0 k_nogate
    v_mul_f32 v116, 0xbfb8aa3b, v28
    v_exp_f32 v116, v116
    s_nop 0
    v_add_f32 v116, 1.0, v116
    v_rcp_f32 v116, v116
    s_mov_b32 exec_lo, 0
    buffer_store_dword v116, v3, s[32:35], s83 offen sc1
    s_mov_b32 exec_lo, -1
k_nogate:
k_setup:
    s_mov_b32 s32, s14
    s_mov_b32 s33, s15
    s_mov_b32 s34, 5242880
    s_mov_b32 s35, 0x20000
    s_lshl_b32 s3, s41, 18
    s_add_u32 s24, s14, s3
    s_addc_u32 s25, s15, 0
    s_mov_b32 s26, 0x40000
    s_mov_b32 s27, 0x20000
    s_and_b32 s44, s40, 1
    s_lshr_b32 s45, s40, 1
    s_and_b32 s46, s40, 3
    s_lshr_b32 s47, s40, 2
    s_cmp_eq_u32 s47, 0
    s_cselect_b32 s28, s8, s10
    s_cselect_b32 s29, s9, s11
    s_mov_b32 s30, 401408
    s_mov_b32 s31, 0x20000
    s_mov_b32 s36, s12
    s_mov_b32 s37, s13
    s_mov_b32 s38, 1835008
    s_mov_b32 s39, 0x20000
    s_lshl_b32 s48, s40, 12
    s_mul_i32 s50, s43, 224
    s_lshl_b32 s3, s46, 6
    s_add_u32 s50, s50, s3
    s_mov_b32 s53, 0
    v_lshrrev_b32 v3, 5, v0
    v_and_b32 v116, 31, v0
    v_bfe_u32 v117, v0, 1, 3
    v_xor_b32 v117, v117, v3
    v_lshlrev_b32 v117, 4, v117
    v_lshl_add_u32 v121, v116, 7, v117
    s_lshl_b32 s3, s44, 12
    s_add_u32 s3, s3, 71936
    v_add_u32 v112, s3, v121
    v_xor_b32 v113, 32, v112
    v_xor_b32 v114, 64, v112
    v_xor_b32 v115, 96, v112
    v_bfe_u32 v4, v0, 4, 1
    v_lshlrev_b32 v4, 5, v4
    v_and_b32 v116, 3, v0
    v_lshl_add_u32 v4, v116, 3, v4
    v_bfe_u32 v116, v0, 2, 2
    v_lshlrev_b32 v117, 1, v116
    v_lshl_add_u32 v117, v3, 3, v117
    v_mul_u32_u24 v108, 224, v117
    v_add_u32 v108, v108, v4
    s_mul_i32 s3, s45, 56
    v_add_u32 v108, s3, v108
    v_add_u32 v109, 57344, v108
    v_add_u32 v110, 129280, v108
    s_mul_i32 s49, s40, 7168
    s_add_u32 s49, s49, 98304
    v_lshl_add_u32 v7, v116, 6, v4
    v_add_u32 v7, s49, v7
    v_lshl_add_u32 v6, v3, 8, v7
    s_mov_b32 s20, s6
    s_mov_b32 s21, s7
    s_mov_b32 s22, 401408
    s_mov_b32 s23, 0x20000
    v_mov_b32 v104, 0
    v_mov_b32 v106, 0
    v_mov_b32 v107, 0
    v_lshl_add_u32 v120, v3, 3, v116
    v_mul_u32_u24 v120, 56, v120
    v_add_u32 v120, v120, v4
    v_add_u32 v120, 129280, v120
    v_lshlrev_b32 v125, 4, v3
    v_add_u32 v125, 158208, v125
    v_lshrrev_b32 v3, 2, v0
    v_mul_u32_u24 v3, 896, v3
    v_and_b32 v4, 3, v0
    v_lshl_add_u32 v111, v4, 4, v3
    s_mul_i32 s5, s41, 16384
    s_add_u32 s5, s5, 557056
    s_lshl_b32 s3, s42, 2
    s_add_u32 s51, s3, s43
    s_lshl_b32 s51, s51, 3
    s_add_u32 s4, s51, s5
    s_lshr_b32 s3, s3, 1
    s_add_u32 s3, s3, s61
    s_lshl_b32 s3, s3, 12
    s_lshl_b32 s51, s41, 18
    s_add_u32 s3, s3, s51
    s_lshr_b32 s51, s43, 1
    s_lshl_b32 s51, s51, 11
    s_add_u32 s82, s3, s51
    s_and_b32 s3, s2, 7
    s_lshl_b32 s3, s3, 1
    s_lshr_b32 s51, s2, 7
    s_add_u32 s3, s3, s51
    s_lshl_b32 s3, s3, 10
    s_add_u32 s5, s5, s3
    s_lshr_b32 s3, s42, 2
    s_and_b32 s3, s3, 7
    s_lshl_b32 s81, s3, 15
    s_add_u32 s81, s81, s48
    s_lshl_b32 s3, s3, 7
    v_xor_b32 v5, s3, v1
    s_lshl_b32 s3, s42, 1
    s_add_u32 s83, s3, s61
    s_lshl_b32 s83, s83, 7
    s_add_u32 s83, s83, 524288
    s_add_u32 s3, s3, s44
    s_lshl_b32 s3, s3, 1
    s_add_u32 s3, s3, s41
    s_lshl_b32 s3, s3, 15
    s_lshl_b32 s51, s43, 2
    s_add_u32 s51, s51, s45
    s_lshl_b32 s51, s51, 11
    s_add_u32 s3, s3, s51
    s_add_u32 s55, s3, 1048576
    s_mov_b32 s56, 0
    s_lshl_b32 s3, s42, 1
    s_add_u32 s3, s3, s41
    s_lshl_b32 s3, s3, 16
    s_add_u32 s57, s3, 1048576
    v_add_u32 v2, 0x10000, v1
    v_mov_b32 v88, 0
    v_mov_b32 v89, 0
    v_mov_b32 v90, 0
    v_mov_b32 v91, 0
    v_mov_b32 v92, 0
    v_mov_b32 v93, 0
    v_mov_b32 v94, 0
    v_mov_b32 v95, 0
    v_mov_b32 v96, 0
    v_mov_b32 v97, 0
    v_mov_b32 v98, 0
    v_mov_b32 v99, 0
    v_mov_b32 v100, 0
    v_mov_b32 v101, 0
    v_mov_b32 v102, 0
    v_mov_b32 v103, 0
    s_cmp_eq_u32 s47, s41
    s_cselect_b32 s65, 1, 0
    s_cselect_b32 s3, s43, 0
    s_lshl_b32 s3, s3, 3
    s_lshr_b32 s64, 0x9372b19c, s3
    s_sub_u32 s74, s50, 256
    s_and_b32 s3, s64, 3
    s_lshl_b32 s70, s3, 13
    s_mul_i32 s3, s3, 100352
    s_add_u32 s66, s3, s74
    s_add_u32 s75, s3, s50
    s_bfe_u32 s3, s64, 0x20002
    s_lshl_b32 s71, s3, 13
    s_mul_i32 s3, s3, 100352
    s_add_u32 s67, s3, s74
    s_bfe_u32 s3, s64, 0x20004
    s_lshl_b32 s72, s3, 13
    s_mul_i32 s3, s3, 100352
    s_add_u32 s68, s3, s74
    s_bfe_u32 s3, s64, 0x20006
    s_lshl_b32 s73, s3, 13
    s_mul_i32 s3, s3, 100352
    s_add_u32 s69, s3, s74
k_q:
    s_setprio 0
    s_barrier
    ds_read_b64_tr_b16 v[128:129], v108
    ds_read_b64_tr_b16 v[130:131], v108 offset:224
    ds_read_b128 v[144:147], v112
    ds_read_b64_tr_b16 v[132:133], v108 offset:3584
    ds_read_b64_tr_b16 v[134:135], v108 offset:3808
    ds_read_b128 v[148:151], v113
    ds_read_b64_tr_b16 v[136:137], v108 offset:7168
    ds_read_b64_tr_b16 v[138:139], v108 offset:7392
    ds_read_b128 v[152:155], v114
    ds_read_b64_tr_b16 v[140:141], v108 offset:10752
    ds_read_b64_tr_b16 v[142:143], v108 offset:10976
    ds_read_b128 v[156:159], v115
    s_cmp_eq_u32 s40, 0
    s_cbranch_scc0 k_nopub
    s_waitcnt vmcnt(0)
    v_readfirstlane_b32 s100, v118
    s_branch k_pv3_over
k_pv3:
    s_branch k_setup
k_pv3_over:
    v_readfirstlane_b32 s101, v119
    v_lshlrev_b32 v116, 10, v0
    s_add_u32 s100, s100, 0x7f4a7c15
    s_addc_u32 s101, s101, 0x9e3779b9
    v_mov_b32 v118, s100
    v_mov_b32 v119, s101
    s_mov_b64 exec, 0xffff
    buffer_store_dwordx2 v[118:119], v116, s[32:35], s4 offen sc1
    s_mov_b64 exec, -1
k_nopub:
    s_waitcnt lgkmcnt(0)
    v_mfma_f32_32x32x16_bf16 v[16:31], v[128:131], v[144:147], 0
    ds_read_b64_tr_b16 v[160:161], v108 offset:14336
    ds_read_b64_tr_b16 v[162:163], v108 offset:14560
    ds_read_b128 v[176:179], v112 offset:8192
    v_mfma_f32_32x32x16_bf16 v[16:31], v[132:135], v[148:151], v[16:31]
    ds_read_b64_tr_b16 v[164:165], v108 offset:17920
    ds_read_b64_tr_b16 v[166:167], v108 offset:18144
    ds_read_b128 v[180:183], v113 offset:8192
    v_mfma_f32_32x32x16_bf16 v[16:31], v[136:139], v[152:155], v[16:31]
    ds_read_b64_tr_b16 v[168:169], v108 offset:21504
    ds_read_b64_tr_b16 v[170:171], v108 offset:21728
    ds_read_b128 v[184:187], v114 offset:8192
    v_mfma_f32_32x32x16_bf16 v[16:31], v[140:143], v[156:159], v[16:31]
    ds_read_b64_tr_b16 v[172:173], v108 offset:25088
    ds_read_b64_tr_b16 v[174:175], v108 offset:25312
    ds_read_b128 v[188:191], v115 offset:8192
    s_barrier
    s_waitcnt lgkmcnt(0)
    v_mfma_f32_32x32x16_bf16 v[16:31], v[160:163], v[176:179], v[16:31]
    ds_read_b64_tr_b16 v[128:129], v108 offset:28672
    ds_read_b64_tr_b16 v[130:131], v108 offset:28896
    ds_read_b128 v[144:147], v112 offset:16384
    v_mfma_f32_32x32x16_bf16 v[16:31], v[164:167], v[180:183], v[16:31]
    ds_read_b64_tr_b16 v[132:133], v108 offset:32256
    ds_read_b64_tr_b16 v[134:135], v108 offset:32480
    ds_read_b128 v[148:151], v113 offset:16384
    v_mfma_f32_32x32x16_bf16 v[16:31], v[168:171], v[184:187], v[16:31]
    ds_read_b64_tr_b16 v[136:137], v108 offset:35840
    ds_read_b64_tr_b16 v[138:139], v108 offset:36064
    ds_read_b128 v[152:155], v114 offset:16384
    v_mfma_f32_32x32x16_bf16 v[16:31], v[172:175], v[188:191], v[16:31]
    ds_read_b64_tr_b16 v[140:141], v108 offset:39424
    ds_read_b64_tr_b16 v[142:143], v108 offset:39648
    ds_read_b128 v[156:159], v115 offset:16384
    s_waitcnt lgkmcnt(0)
    v_mfma_f32_32x32x16_bf16 v[16:31], v[128:131], v[144:147], v[16:31]
    ds_read_b64_tr_b16 v[160:161], v108 offset:43008
    ds_read_b64_tr_b16 v[162:163], v108 offset:43232
    ds_read_b128 v[176:179], v112 offset:24576
    v_mfma_f32_32x32x16_bf16 v[16:31], v[132:135], v[148:151], v[16:31]
    ds_read_b64_tr_b16 v[164:165], v108 offset:46592
    ds_read_b64_tr_b16 v[166:167], v108 offset:46816
    ds_read_b128 v[180:183], v113 offset:24576
    v_mfma_f32_32x32x16_bf16 v[16:31], v[136:139], v[152:155], v[16:31]
    ds_read_b64_tr_b16 v[168:169], v108 offset:50176
    ds_read_b64_tr_b16 v[170:171], v108 offset:50400
    ds_read_b128 v[184:187], v114 offset:24576
    v_mfma_f32_32x32x16_bf16 v[16:31], v[140:143], v[156:159], v[16:31]
    ds_read_b64_tr_b16 v[172:173], v108 offset:53760
    ds_read_b64_tr_b16 v[174:175], v108 offset:53984
    ds_read_b128 v[188:191], v115 offset:24576
    s_waitcnt lgkmcnt(0)
    v_mfma_f32_32x32x16_bf16 v[16:31], v[160:163], v[176:179], v[16:31]
    ds_read_b64_tr_b16 v[128:129], v109
    ds_read_b64_tr_b16 v[130:131], v109 offset:224
    ds_read_b128 v[144:147], v112 offset:32768
    v_mfma_f32_32x32x16_bf16 v[16:31], v[164:167], v[180:183], v[16:31]
    ds_read_b64_tr_b16 v[132:133], v109 offset:3584
    ds_read_b64_tr_b16 v[134:135], v109 offset:3808
    ds_read_b128 v[148:151], v113 offset:32768
    v_mfma_f32_32x32x16_bf16 v[16:31], v[168:171], v[184:187], v[16:31]
    ds_read_b64_tr_b16 v[136:137], v109 offset:7168
    ds_read_b64_tr_b16 v[138:139], v109 offset:7392
    ds_read_b128 v[152:155], v114 offset:32768
    v_mfma_f32_32x32x16_bf16 v[16:31], v[172:175], v[188:191], v[16:31]
    ds_read_b64_tr_b16 v[140:141], v109 offset:10752
    ds_read_b64_tr_b16 v[142:143], v109 offset:10976
    ds_read_b128 v[156:159], v115 offset:32768
    s_cmp_eq_u32 s40, 0
    s_cbranch_scc0 k_np4b
    s_mov_b64 exec, 0xff
    buffer_load_dwordx4 v[72:75], v5, s[32:35], s5 offen sc1
    s_mov_b64 exec, -1
k_np4b:
    s_barrier
    s_waitcnt lgkmcnt(0)
    v_mfma_f32_32x32x16_bf16 v[16:31], v[128:131], v[144:147], v[16:31]
    ds_read_b64_tr_b16 v[160:161], v110
    ds_read_b64_tr_b16 v[162:163], v110 offset:224
    ds_read_b128 v[176:179], v112 offset:40960
    v_mfma_f32_32x32x16_bf16 v[16:31], v[132:135], v[148:151], v[16:31]
    ds_read_b64_tr_b16 v[164:165], v110 offset:3584
    ds_read_b64_tr_b16 v[166:167], v110 offset:3808
    ds_read_b128 v[180:183], v113 offset:40960
    v_mfma_f32_32x32x16_bf16 v[16:31], v[136:139], v[152:155], v[16:31]
    ds_read_b64_tr_b16 v[168:169], v110 offset:7168
    ds_read_b64_tr_b16 v[170:171], v110 offset:7392
    ds_read_b128 v[184:187], v114 offset:40960
    v_mfma_f32_32x32x16_bf16 v[16:31], v[140:143], v[156:159], v[16:31]
    ds_read_b64_tr_b16 v[172:173], v110 offset:10752
    ds_read_b64_tr_b16 v[174:175], v110 offset:10976
    ds_read_b128 v[188:191], v115 offset:40960
    s_waitcnt lgkmcnt(0)
    s_cmp_eq_u32 s40, 0
    s_cbranch_scc0 k_kvseen
    s_waitcnt vmcnt(0)
    v_cmp_ne_u64 vcc, s[100:101], v[72:73]
    v_cmp_ne_u64 s[62:63], s[100:101], v[74:75]
    s_or_b64 vcc, vcc, s[62:63]
    s_and_b32 s62, vcc_lo, 0xff
    s_cbranch_scc0 k_kvp_ok
    s_mov_b32 s52, 0
k_kvp_ld:
    s_mov_b64 exec, 0xff
    buffer_load_dwordx4 v[72:75], v5, s[32:35], s5 offen sc1
    s_mov_b64 exec, -1
    s_add_u32 s52, s52, 1
    s_waitcnt vmcnt(0)
    v_cmp_ne_u64 vcc, s[100:101], v[72:73]
    v_cmp_ne_u64 s[62:63], s[100:101], v[74:75]
    s_or_b64 vcc, vcc, s[62:63]
    s_and_b32 s62, vcc_lo, 0xff
    s_cbranch_scc0 k_kvp_ok
    s_cmp_lt_u32 s52, 0x40000
    s_cbranch_scc1 k_kvp_ld
k_kvp_ok:
k_kvseen:
    s_barrier
    s_add_u32 m0, s48, 0
    s_xor_b32 s51, s81, 0
    s_nop 0
    buffer_load_dwordx4 v1, s[24:27], s51 offen sc1 lds
    buffer_load_dwordx4 v1, s[24:27], s51 offen offset:1024 sc1 lds
    buffer_load_dwordx4 v1, s[24:27], s51 offen offset:2048 sc1 lds
    buffer_load_dwordx4 v1, s[24:27], s51 offen offset:3072 sc1 lds
    s_cmp_eq_u32 s40, 0
    s_cbranch_scc0 k_npd
    s_mov_b64 exec, 0xffffff
    buffer_load_dwordx4 v[84:87], v5, s[32:35], s5 offen sc1
    s_mov_b64 exec, -1
k_npd:
    v_mfma_f32_32x32x16_bf16 v[16:31], v[160:163], v[176:179], v[16:31]
    ds_read_b64_tr_b16 v[128:129], v110 offset:14336
    ds_read_b64_tr_b16 v[130:131], v110 offset:14560
    ds_read_b128 v[144:147], v112 offset:49152
    v_mfma_f32_32x32x16_bf16 v[16:31], v[164:167], v[180:183], v[16:31]
    ds_read_b64_tr_b16 v[132:133], v110 offset:17920
    ds_read_b64_tr_b16 v[134:135], v110 offset:18144
    ds_read_b128 v[148:151], v113 offset:49152
    v_mfma_f32_32x32x16_bf16 v[16:31], v[168:171], v[184:187], v[16:31]
    ds_read_b64_tr_b16 v[136:137], v110 offset:21504
    ds_read_b64_tr_b16 v[138:139], v110 offset:21728
    ds_read_b128 v[152:155], v114 offset:49152
    v_mfma_f32_32x32x16_bf16 v[16:31], v[172:175], v[188:191], v[16:31]
    ds_read_b64_tr_b16 v[140:141], v110 offset:25088
    ds_read_b64_tr_b16 v[142:143], v110 offset:25312
    ds_read_b128 v[156:159], v115 offset:49152
k_qt:
    s_waitcnt lgkmcnt(0)
    v_mfma_f32_32x32x16_bf16 v[16:31], v[128:131], v[144:147], v[16:31]
    v_mfma_f32_32x32x16_bf16 v[16:31], v[132:135], v[148:151], v[16:31]
    v_mfma_f32_32x32x16_bf16 v[16:31], v[136:139], v[152:155], v[16:31]
    v_mfma_f32_32x32x16_bf16 v[16:31], v[140:143], v[156:159], v[16:31]
    s_nop 7
    s_nop 3
    s_mov_b32 s52, 0x3e8b97f6
    v_mul_f32 v16, s52, v16
    v_mul_f32 v17, s52, v17
    v_mul_f32 v18, s52, v18
    v_mul_f32 v19, s52, v19
    v_mul_f32 v20, s52, v20
    v_mul_f32 v21, s52, v21
    v_mul_f32 v22, s52, v22
    v_mul_f32 v23, s52, v23
    v_mul_f32 v24, s52, v24
    v_mul_f32 v25, s52, v25
    v_mul_f32 v26, s52, v26
    v_mul_f32 v27, s52, v27
    v_mul_f32 v28, s52, v28
    v_mul_f32 v29, s52, v29
    v_mul_f32 v30, s52, v30
    v_mul_f32 v31, s52, v31
    v_cvt_pk_bf16_f32 v8, v16, v17
    v_cvt_pk_bf16_f32 v9, v18, v19
    v_cvt_pk_bf16_f32 v10, v20, v21
    v_cvt_pk_bf16_f32 v11, v22, v23
    v_cvt_pk_bf16_f32 v12, v24, v25
    v_cvt_pk_bf16_f32 v13, v26, v27
    v_cvt_pk_bf16_f32 v14, v28, v29
    v_cvt_pk_bf16_f32 v15, v30, v31
    s_mov_b32 exec_lo, 0
    v_mov_b32 v14, 0
    v_mov_b32 v15, 0
    s_mov_b32 exec_lo, -1
k_attn:
    v_bfe_u32 v116, v0, 2, 2
    v_lshlrev_b32 v116, 3, v116
    s_mov_b32 s3, 0x040f0211
    v_bfe_u32 v116, s3, v116, 8
    v_lshrrev_b32 v117, 5, v0
    v_mul_u32_u24 v116, v116, v117
    v_lshlrev_b32 v116, 6, v116
    v_sub_u32 v7, v6, v116
    s_waitcnt vmcnt(0) lgkmcnt(0)
    s_cmp_eq_u32 s40, 0
    s_cbranch_scc0 k_kv1seen
    s_waitcnt vmcnt(0)
    v_cmp_ne_u64 vcc, s[100:101], v[84:85]
    v_cmp_ne_u64 s[62:63], s[100:101], v[86:87]
    s_or_b64 vcc, vcc, s[62:63]
    s_and_b32 s62, vcc_lo, 0xffffff
    s_cbranch_scc0 k_kv1p_ok
    s_mov_b32 s52, 0
k_kv1p_ld:
    s_mov_b64 exec, 0xffffff
    buffer_load_dwordx4 v[84:87], v5, s[32:35], s5 offen sc1
    s_mov_b64 exec, -1
    s_add_u32 s52, s52, 1
    s_waitcnt vmcnt(0)
    v_cmp_ne_u64 vcc, s[100:101], v[84:85]
    v_cmp_ne_u64 s[62:63], s[100:101], v[86:87]
    s_or_b64 vcc, vcc, s[62:63]
    s_and_b32 s62, vcc_lo, 0xffffff
    s_cbranch_scc0 k_kv1p_ok
    s_cmp_lt_u32 s52, 0x40000
    s_cbranch_scc1 k_kv1p_ld
k_kv1p_ok:
k_kv1seen:
    s_barrier
    ds_read_b128 v[72:75], v1
    ds_read_b128 v[76:79], v1 offset:1024
    s_waitcnt lgkmcnt(0)
    v_mfma_f32_32x32x16_bf16 v[16:31], v[72:75], v[8:11], v[88:103]
    v_mfma_f32_32x32x16_bf16 v[16:31], v[76:79], v[12:15], v[16:31]
    ds_read_b128 v[72:75], v1 offset:4096
    ds_read_b128 v[76:79], v1 offset:5120
    ds_read_b128 v[80:83], v1 offset:2048
    s_add_u32 m0, s48, 32768
    s_xor_b32 s51, s81, 32768
    s_nop 0
    buffer_load_dwordx4 v1, s[24:27], s51 offen sc1 lds
    buffer_load_dwordx4 v1, s[24:27], s51 offen offset:1024 sc1 lds
    buffer_load_dwordx4 v1, s[24:27], s51 offen offset:2048 sc1 lds
    buffer_load_dwordx4 v1, s[24:27], s51 offen offset:3072 sc1 lds
    s_nop 7
    s_nop 3
    s_setprio 3
    s_cmp_eq_u32 s40, 0
    s_cbranch_scc0 k_nop3
    buffer_load_dwordx4 v[128:131], v5, s[32:35], s5 offen sc1
    v_and_b32 v104, 3, v0
    v_lshlrev_b32 v105, 4, v104
    v_mov_b32 v106, s100
    v_mov_b32 v107, s101
    v_lshrrev_b64 v[106:107], v105, v[106:107]
    v_lshlrev_b32 v104, 2, v104
    v_lshlrev_b32 v106, 16, v106
    v_add_u32 v104, 159808, v104
    v_and_b32 v106, 0x9fff0000, v106
    v_or_b32 v106, 0x20000000, v106
    ds_write_b32 v104, v106
k_nop3:
    s_add_u32 m0, s48, 65536
    s_xor_b32 s51, s81, 65536
    s_waitcnt lgkmcnt(2)
    v_mfma_f32_32x32x16_bf16 v[32:47], v[72:75], v[8:11], v[88:103]
    ds_read_b128 v[72:75], v1 offset:8192
    v_exp_f32 v16, v16
    v_exp_f32 v17, v17
    v_exp_f32 v18, v18
    v_cvt_pk_bf16_f32 v48, v16, v17
    v_exp_f32 v19, v19
    ds_read_b128 v[84:87], v1 offset:3072
    buffer_load_dwordx4 v1, s[24:27], s51 offen sc1 lds
    v_exp_f32 v20, v20
    v_cvt_pk_bf16_f32 v49, v18, v19
    v_exp_f32 v21, v21
    v_exp_f32 v22, v22
    v_cvt_pk_bf16_f32 v50, v20, v21
    v_exp_f32 v23, v23
    s_waitcnt lgkmcnt(2)
    v_mfma_f32_32x32x16_bf16 v[32:47], v[76:79], v[12:15], v[32:47]
    ds_read_b128 v[76:79], v1 offset:9216
    v_exp_f32 v24, v24
    v_cvt_pk_bf16_f32 v51, v22, v23
    v_exp_f32 v25, v25
    v_exp_f32 v26, v26
    v_cvt_pk_bf16_f32 v52, v24, v25
    v_exp_f32 v27, v27
    v_mfma_f32_32x32x16_bf16 v[56:71], v[80:83], v[48:51], 0
    ds_read_b128 v[80:83], v1 offset:6144
    v_exp_f32 v28, v28
    v_cvt_pk_bf16_f32 v53, v26, v27
    v_exp_f32 v29, v29
    v_exp_f32 v30, v30
    v_exp_f32 v31, v31
    v_cvt_pk_bf16_f32 v54, v28, v29
    v_cvt_pk_bf16_f32 v55, v30, v31
    s_waitcnt lgkmcnt(2)
    v_mfma_f32_32x32x16_bf16 v[16:31], v[72:75], v[8:11], v[88:103]
    ds_read_b128 v[72:75], v1 offset:12288
    v_exp_f32 v32, v32
    v_exp_f32 v33, v33
    v_exp_f32 v34, v34
    v_cvt_pk_bf16_f32 v48, v32, v33
    v_exp_f32 v35, v35
    v_mfma_f32_32x32x16_bf16 v[56:71], v[84:87], v[52:55], v[56:71]
    ds_read_b128 v[84:87], v1 offset:7168
    buffer_load_dwordx4 v1, s[24:27], s51 offen offset:1024 sc1 lds
    v_exp_f32 v36, v36
    v_cvt_pk_bf16_f32 v49, v34, v35
    v_exp_f32 v37, v37
    v_exp_f32 v38, v38
    v_cvt_pk_bf16_f32 v50, v36, v37
    v_exp_f32 v39, v39
    s_waitcnt lgkmcnt(2)
    v_mfma_f32_32x32x16_bf16 v[16:31], v[76:79], v[12:15], v[16:31]
    ds_read_b128 v[76:79], v1 offset:13312
    v_exp_f32 v40, v40
    v_cvt_pk_bf16_f32 v51, v38, v39
    v_exp_f32 v41, v41
    v_exp_f32 v42, v42
    v_cvt_pk_bf16_f32 v52, v40, v41
    v_exp_f32 v43, v43
    v_mfma_f32_32x32x16_bf16 v[56:71], v[80:83], v[48:51], v[56:71]
    ds_read_b128 v[80:83], v1 offset:10240
    v_exp_f32 v44, v44
    v_cvt_pk_bf16_f32 v53, v42, v43
    v_exp_f32 v45, v45
    v_exp_f32 v46, v46
    v_exp_f32 v47, v47
    v_cvt_pk_bf16_f32 v54, v44, v45
    v_cvt_pk_bf16_f32 v55, v46, v47
    s_setprio 2
    s_waitcnt lgkmcnt(2)
    v_mfma_f32_32x32x16_bf16 v[32:47], v[72:75], v[8:11], v[88:103]
    ds_read_b128 v[72:75], v1 offset:16384
    v_exp_f32 v16, v16
    v_exp_f32 v17, v17
    v_exp_f32 v18, v18
    v_cvt_pk_bf16_f32 v48, v16, v17
    v_exp_f32 v19, v19
    v_mfma_f32_32x32x16_bf16 v[56:71], v[84:87], v[52:55], v[56:71]
    ds_read_b128 v[84:87], v1 offset:11264
    buffer_load_dwordx4 v1, s[24:27], s51 offen offset:2048 sc1 lds
    v_exp_f32 v20, v20
    v_cvt_pk_bf16_f32 v49, v18, v19
    v_exp_f32 v21, v21
    v_exp_f32 v22, v22
    v_cvt_pk_bf16_f32 v50, v20, v21
    v_exp_f32 v23, v23
    s_waitcnt lgkmcnt(2)
    v_mfma_f32_32x32x16_bf16 v[32:47], v[76:79], v[12:15], v[32:47]
    ds_read_b128 v[76:79], v1 offset:17408
    v_exp_f32 v24, v24
    v_cvt_pk_bf16_f32 v51, v22, v23
    v_exp_f32 v25, v25
    v_exp_f32 v26, v26
    v_cvt_pk_bf16_f32 v52, v24, v25
    v_exp_f32 v27, v27
    v_mfma_f32_32x32x16_bf16 v[56:71], v[80:83], v[48:51], v[56:71]
    ds_read_b128 v[80:83], v1 offset:14336
    v_exp_f32 v28, v28
    v_cvt_pk_bf16_f32 v53, v26, v27
    v_exp_f32 v29, v29
    v_exp_f32 v30, v30
    v_exp_f32 v31, v31
    v_cvt_pk_bf16_f32 v54, v28, v29
    v_cvt_pk_bf16_f32 v55, v30, v31
    s_waitcnt lgkmcnt(2)
    v_mfma_f32_32x32x16_bf16 v[16:31], v[72:75], v[8:11], v[88:103]
    ds_read_b128 v[72:75], v1 offset:20480
    v_exp_f32 v32, v32
    v_exp_f32 v33, v33
    v_exp_f32 v34, v34
    v_cvt_pk_bf16_f32 v48, v32, v33
    v_exp_f32 v35, v35
    v_mfma_f32_32x32x16_bf16 v[56:71], v[84:87], v[52:55], v[56:71]
    ds_read_b128 v[84:87], v1 offset:15360
    buffer_load_dwordx4 v1, s[24:27], s51 offen offset:3072 sc1 lds
    v_exp_f32 v36, v36
    v_cvt_pk_bf16_f32 v49, v34, v35
    v_exp_f32 v37, v37
    v_exp_f32 v38, v38
    v_cvt_pk_bf16_f32 v50, v36, v37
    v_exp_f32 v39, v39
    s_waitcnt lgkmcnt(2)
    v_mfma_f32_32x32x16_bf16 v[16:31], v[76:79], v[12:15], v[16:31]
    ds_read_b128 v[76:79], v1 offset:21504
    v_exp_f32 v40, v40
    v_cvt_pk_bf16_f32 v51, v38, v39
    v_exp_f32 v41, v41
    v_exp_f32 v42, v42
    v_cvt_pk_bf16_f32 v52, v40, v41
    v_exp_f32 v43, v43
    v_mfma_f32_32x32x16_bf16 v[56:71], v[80:83], v[48:51], v[56:71]
    ds_read_b128 v[80:83], v1 offset:18432
    v_exp_f32 v44, v44
    v_cvt_pk_bf16_f32 v53, v42, v43
    v_exp_f32 v45, v45
    v_exp_f32 v46, v46
    v_exp_f32 v47, v47
    v_cvt_pk_bf16_f32 v54, v44, v45
    v_cvt_pk_bf16_f32 v55, v46, v47
    s_setprio 1
    s_waitcnt lgkmcnt(2)
    v_mfma_f32_32x32x16_bf16 v[32:47], v[72:75], v[8:11], v[88:103]
    ds_read_b128 v[72:75], v1 offset:24576
    v_exp_f32 v16, v16
    v_exp_f32 v17, v17
    v_exp_f32 v18, v18
    v_cvt_pk_bf16_f32 v48, v16, v17
    v_exp_f32 v19, v19
    v_mfma_f32_32x32x16_bf16 v[56:71], v[84:87], v[52:55], v[56:71]
    ds_read_b128 v[84:87], v1 offset:19456
    s_add_u32 m0, s49, 0
    s_add_u32 s52, s75, 0
    v_exp_f32 v20, v20
    buffer_load_dwordx4 v111, s[28:31], s52 offen lds
    v_cvt_pk_bf16_f32 v49, v18, v19
    v_exp_f32 v21, v21
    v_exp_f32 v22, v22
    v_cvt_pk_bf16_f32 v50, v20, v21
    v_exp_f32 v23, v23
    s_waitcnt lgkmcnt(2)
    v_mfma_f32_32x32x16_bf16 v[32:47], v[76:79], v[12:15], v[32:47]
    ds_read_b128 v[76:79], v1 offset:25600
    s_add_u32 m0, s49, 1024
    s_add_u32 s52, s66, 14592
    v_exp_f32 v24, v24
    buffer_load_dwordx4 v111, s[28:31], s52 offen lds
    v_cvt_pk_bf16_f32 v51, v22, v23
    v_exp_f32 v25, v25
    v_exp_f32 v26, v26
    v_cvt_pk_bf16_f32 v52, v24, v25
    v_exp_f32 v27, v27
    v_mfma_f32_32x32x16_bf16 v[56:71], v[80:83], v[48:51], v[56:71]
    ds_read_b128 v[80:83], v1 offset:22528
    v_exp_f32 v28, v28
    v_cvt_pk_bf16_f32 v53, v26, v27
    v_exp_f32 v29, v29
    v_exp_f32 v30, v30
    v_exp_f32 v31, v31
    v_cvt_pk_bf16_f32 v54, v28, v29
    v_cvt_pk_bf16_f32 v55, v30, v31
    s_waitcnt lgkmcnt(2)
    v_mfma_f32_32x32x16_bf16 v[16:31], v[72:75], v[8:11], v[88:103]
    ds_read_b128 v[72:75], v1 offset:28672
    v_exp_f32 v32, v32
    v_exp_f32 v33, v33
    v_exp_f32 v34, v34
    v_cvt_pk_bf16_f32 v48, v32, v33
    v_exp_f32 v35, v35
    v_mfma_f32_32x32x16_bf16 v[56:71], v[84:87], v[52:55], v[56:71]
    ds_read_b128 v[84:87], v1 offset:23552
    s_add_u32 m0, s49, 2048
    s_add_u32 s52, s66, 28928
    v_exp_f32 v36, v36
    buffer_load_dwordx4 v111, s[28:31], s52 offen lds
    v_cvt_pk_bf16_f32 v49, v34, v35
    v_exp_f32 v37, v37
    v_exp_f32 v38, v38
    v_cvt_pk_bf16_f32 v50, v36, v37
    v_exp_f32 v39, v39
    s_waitcnt lgkmcnt(2)
    v_mfma_f32_32x32x16_bf16 v[16:31], v[76:79], v[12:15], v[16:31]
    ds_read_b128 v[76:79], v1 offset:29696
    s_add_u32 m0, s49, 3072
    s_add_u32 s52, s66, 43264
    v_exp_f32 v40, v40
    buffer_load_dwordx4 v111, s[28:31], s52 offen lds
    v_cvt_pk_bf16_f32 v51, v38, v39
    v_exp_f32 v41, v41
    v_exp_f32 v42, v42
    v_cvt_pk_bf16_f32 v52, v40, v41
    v_exp_f32 v43, v43
    v_mfma_f32_32x32x16_bf16 v[56:71], v[80:83], v[48:51], v[56:71]
    ds_read_b128 v[80:83], v1 offset:26624
    v_exp_f32 v44, v44
    v_cvt_pk_bf16_f32 v53, v42, v43
    v_exp_f32 v45, v45
    v_exp_f32 v46, v46
    v_exp_f32 v47, v47
    v_cvt_pk_bf16_f32 v54, v44, v45
    v_cvt_pk_bf16_f32 v55, v46, v47
    s_waitcnt vmcnt(8)
    s_barrier
    s_setprio 0
    s_waitcnt lgkmcnt(2)
    v_mfma_f32_32x32x16_bf16 v[32:47], v[72:75], v[8:11], v[88:103]
    ds_read_b128 v[72:75], v1 offset:32768
    s_branch k_pv4_over
k_pv4:
    s_branch k_setup
k_pv4_over:
    v_exp_f32 v16, v16
    v_exp_f32 v17, v17
    v_exp_f32 v18, v18
    v_cvt_pk_bf16_f32 v48, v16, v17
    v_exp_f32 v19, v19
    v_mfma_f32_32x32x16_bf16 v[56:71], v[84:87], v[52:55], v[56:71]
    ds_read_b128 v[84:87], v1 offset:27648
    s_add_u32 m0, s49, 4096
    s_add_u32 s52, s66, 57600
    v_exp_f32 v20, v20
    buffer_load_dwordx4 v111, s[28:31], s52 offen lds
    v_cvt_pk_bf16_f32 v49, v18, v19
    v_exp_f32 v21, v21
    v_exp_f32 v22, v22
    v_cvt_pk_bf16_f32 v50, v20, v21
    v_exp_f32 v23, v23
    s_waitcnt lgkmcnt(2)
    v_mfma_f32_32x32x16_bf16 v[32:47], v[76:79], v[12:15], v[32:47]
    ds_read_b128 v[76:79], v1 offset:33792
    s_add_u32 m0, s49, 5120
    s_add_u32 s52, s66, 71936
    v_exp_f32 v24, v24
    buffer_load_dwordx4 v111, s[28:31], s52 offen lds
    v_cvt_pk_bf16_f32 v51, v22, v23
    v_exp_f32 v25, v25
    v_exp_f32 v26, v26
    v_cvt_pk_bf16_f32 v52, v24, v25
    v_exp_f32 v27, v27
    v_mfma_f32_32x32x16_bf16 v[56:71], v[80:83], v[48:51], v[56:71]
    ds_read_b128 v[80:83], v1 offset:30720
    v_exp_f32 v28, v28
    v_cvt_pk_bf16_f32 v53, v26, v27
    v_exp_f32 v29, v29
    v_exp_f32 v30, v30
    v_exp_f32 v31, v31
    v_cvt_pk_bf16_f32 v54, v28, v29
    v_cvt_pk_bf16_f32 v55, v30, v31
    s_waitcnt lgkmcnt(2)
    v_mfma_f32_32x32x16_bf16 v[16:31], v[72:75], v[8:11], v[88:103]
    ds_read_b128 v[72:75], v1 offset:36864
    v_exp_f32 v32, v32
    v_exp_f32 v33, v33
    v_exp_f32 v34, v34
    v_cvt_pk_bf16_f32 v48, v32, v33
    v_exp_f32 v35, v35
    v_mfma_f32_32x32x16_bf16 v[56:71], v[84:87], v[52:55], v[56:71]
    ds_read_b128 v[84:87], v1 offset:31744
    s_add_u32 m0, s49, 6144
    s_add_u32 s52, s66, 86272
    v_exp_f32 v36, v36
    buffer_load_dwordx4 v111, s[28:31], s52 offen lds
    v_cvt_pk_bf16_f32 v49, v34, v35
    v_exp_f32 v37, v37
    v_exp_f32 v38, v38
    v_cvt_pk_bf16_f32 v50, v36, v37
    v_exp_f32 v39, v39
    s_waitcnt lgkmcnt(2)
    v_mfma_f32_32x32x16_bf16 v[16:31], v[76:79], v[12:15], v[16:31]
    ds_read_b128 v[76:79], v1 offset:37888
    v_exp_f32 v40, v40
    v_cvt_pk_bf16_f32 v51, v38, v39
    v_exp_f32 v41, v41
    v_exp_f32 v42, v42
    v_cvt_pk_bf16_f32 v52, v40, v41
    v_exp_f32 v43, v43
    v_mfma_f32_32x32x16_bf16 v[56:71], v[80:83], v[48:51], v[56:71]
    ds_read_b128 v[80:83], v1 offset:34816
    v_exp_f32 v44, v44
    v_cvt_pk_bf16_f32 v53, v42, v43
    v_exp_f32 v45, v45
    v_exp_f32 v46, v46
    v_exp_f32 v47, v47
    v_cvt_pk_bf16_f32 v54, v44, v45
    v_cvt_pk_bf16_f32 v55, v46, v47
    s_waitcnt vmcnt(7) lgkmcnt(2)
    s_cmp_eq_u32 s40, 0
    s_cbranch_scc0 k_allseen
    s_waitcnt vmcnt(7)
    v_cmp_ne_u64 vcc, s[100:101], v[128:129]
    v_cmp_ne_u64 s[62:63], s[100:101], v[130:131]
    s_or_b64 vcc, vcc, s[62:63]
    s_cmp_lg_u64 vcc, 0
    s_cbranch_scc0 k_allp_ok
    s_mov_b32 s52, 0
k_allp_ld:
    buffer_load_dwordx4 v[128:131], v5, s[32:35], s5 offen sc1
    s_add_u32 s52, s52, 1
    s_waitcnt vmcnt(0)
    v_cmp_ne_u64 vcc, s[100:101], v[128:129]
    v_cmp_ne_u64 s[62:63], s[100:101], v[130:131]
    s_or_b64 vcc, vcc, s[62:63]
    s_cmp_lg_u64 vcc, 0
    s_cbranch_scc0 k_allp_ok
    s_cmp_lt_u32 s52, 0x40000
    s_cbranch_scc1 k_allp_ld
k_allp_ok:
k_allseen:
    s_barrier
    s_setprio 3
    s_add_u32 m0, s48, 0
    s_xor_b32 s51, s81, 98304
    v_mfma_f32_32x32x16_bf16 v[32:47], v[72:75], v[8:11], v[88:103]
    ds_read_b128 v[72:75], v1 offset:40960
    v_exp_f32 v16, v16
    v_exp_f32 v17, v17
    v_exp_f32 v18, v18
    v_cvt_pk_bf16_f32 v48, v16, v17
    v_exp_f32 v19, v19
    v_mfma_f32_32x32x16_bf16 v[56:71], v[84:87], v[52:55], v[56:71]
    ds_read_b128 v[84:87], v1 offset:35840
    buffer_load_dwordx4 v1, s[24:27], s51 offen sc1 lds
    v_exp_f32 v20, v20
    v_cvt_pk_bf16_f32 v49, v18, v19
    v_exp_f32 v21, v21
    v_exp_f32 v22, v22
    v_cvt_pk_bf16_f32 v50, v20, v21
    v_exp_f32 v23, v23
    s_waitcnt lgkmcnt(2)
    v_mfma_f32_32x32x16_bf16 v[32:47], v[76:79], v[12:15], v[32:47]
    ds_read_b128 v[76:79], v1 offset:41984
    v_exp_f32 v24, v24
    v_cvt_pk_bf16_f32 v51, v22, v23
    v_exp_f32 v25, v25
    v_exp_f32 v26, v26
    v_cvt_pk_bf16_f32 v52, v24, v25
    v_exp_f32 v27, v27
    v_mfma_f32_32x32x16_bf16 v[56:71], v[80:83], v[48:51], v[56:71]
    ds_read_b128 v[80:83], v1 offset:38912
    v_exp_f32 v28, v28
    v_cvt_pk_bf16_f32 v53, v26, v27
    v_exp_f32 v29, v29
    v_exp_f32 v30, v30
    v_exp_f32 v31, v31
    v_cvt_pk_bf16_f32 v54, v28, v29
    v_cvt_pk_bf16_f32 v55, v30, v31
    s_waitcnt lgkmcnt(2)
    v_mfma_f32_32x32x16_bf16 v[16:31], v[72:75], v[8:11], v[88:103]
    ds_read_b128 v[72:75], v1 offset:45056
    v_exp_f32 v32, v32
    v_exp_f32 v33, v33
    v_exp_f32 v34, v34
    v_cvt_pk_bf16_f32 v48, v32, v33
    v_exp_f32 v35, v35
    v_mfma_f32_32x32x16_bf16 v[56:71], v[84:87], v[52:55], v[56:71]
    ds_read_b128 v[84:87], v1 offset:39936
    buffer_load_dwordx4 v1, s[24:27], s51 offen offset:1024 sc1 lds
    v_exp_f32 v36, v36
    v_cvt_pk_bf16_f32 v49, v34, v35
    v_exp_f32 v37, v37
    v_exp_f32 v38, v38
    v_cvt_pk_bf16_f32 v50, v36, v37
    v_exp_f32 v39, v39
    s_waitcnt lgkmcnt(2)
    v_mfma_f32_32x32x16_bf16 v[16:31], v[76:79], v[12:15], v[16:31]
    ds_read_b128 v[76:79], v1 offset:46080
    v_exp_f32 v40, v40
    v_cvt_pk_bf16_f32 v51, v38, v39
    v_exp_f32 v41, v41
    v_exp_f32 v42, v42
    v_cvt_pk_bf16_f32 v52, v40, v41
    v_exp_f32 v43, v43
    v_mfma_f32_32x32x16_bf16 v[56:71], v[80:83], v[48:51], v[56:71]
    ds_read_b128 v[80:83], v1 offset:43008
    v_exp_f32 v44, v44
    v_cvt_pk_bf16_f32 v53, v42, v43
    v_exp_f32 v45, v45
    v_exp_f32 v46, v46
    v_exp_f32 v47, v47
    v_cvt_pk_bf16_f32 v54, v44, v45
    v_cvt_pk_bf16_f32 v55, v46, v47
    s_setprio 2
    s_waitcnt lgkmcnt(2)
    v_mfma_f32_32x32x16_bf16 v[32:47], v[72:75], v[8:11], v[88:103]
    ds_read_b128 v[72:75], v1 offset:49152
    v_exp_f32 v16, v16
    v_exp_f32 v17, v17
    v_exp_f32 v18, v18
    v_cvt_pk_bf16_f32 v48, v16, v17
    v_exp_f32 v19, v19
    v_mfma_f32_32x32x16_bf16 v[56:71], v[84:87], v[52:55], v[56:71]
    ds_read_b128 v[84:87], v1 offset:44032
    buffer_load_dwordx4 v1, s[24:27], s51 offen offset:2048 sc1 lds
    v_exp_f32 v20, v20
    v_cvt_pk_bf16_f32 v49, v18, v19
    v_exp_f32 v21, v21
    v_exp_f32 v22, v22
    v_cvt_pk_bf16_f32 v50, v20, v21
    v_exp_f32 v23, v23
    s_waitcnt lgkmcnt(2)
    v_mfma_f32_32x32x16_bf16 v[32:47], v[76:79], v[12:15], v[32:47]
    ds_read_b128 v[76:79], v1 offset:50176
    v_exp_f32 v24, v24
    v_cvt_pk_bf16_f32 v51, v22, v23
    v_exp_f32 v25, v25
    v_exp_f32 v26, v26
    v_cvt_pk_bf16_f32 v52, v24, v25
    v_exp_f32 v27, v27
    v_mfma_f32_32x32x16_bf16 v[56:71], v[80:83], v[48:51], v[56:71]
    ds_read_b128 v[80:83], v1 offset:47104
    v_exp_f32 v28, v28
    v_cvt_pk_bf16_f32 v53, v26, v27
    v_exp_f32 v29, v29
    v_exp_f32 v30, v30
    v_exp_f32 v31, v31
    v_cvt_pk_bf16_f32 v54, v28, v29
    v_cvt_pk_bf16_f32 v55, v30, v31
    s_waitcnt lgkmcnt(2)
    v_mfma_f32_32x32x16_bf16 v[16:31], v[72:75], v[8:11], v[88:103]
    ds_read_b128 v[72:75], v1 offset:53248
    v_exp_f32 v32, v32
    v_exp_f32 v33, v33
    v_exp_f32 v34, v34
    v_cvt_pk_bf16_f32 v48, v32, v33
    v_exp_f32 v35, v35
    v_mfma_f32_32x32x16_bf16 v[56:71], v[84:87], v[52:55], v[56:71]
    ds_read_b128 v[84:87], v1 offset:48128
    buffer_load_dwordx4 v1, s[24:27], s51 offen offset:3072 sc1 lds
    v_exp_f32 v36, v36
    v_cvt_pk_bf16_f32 v49, v34, v35
    v_exp_f32 v37, v37
    v_exp_f32 v38, v38
    v_cvt_pk_bf16_f32 v50, v36, v37
    v_exp_f32 v39, v39
    s_waitcnt lgkmcnt(2)
    v_mfma_f32_32x32x16_bf16 v[16:31], v[76:79], v[12:15], v[16:31]
    ds_read_b128 v[76:79], v1 offset:54272
    v_exp_f32 v40, v40
    v_cvt_pk_bf16_f32 v51, v38, v39
    v_exp_f32 v41, v41
    v_exp_f32 v42, v42
    v_cvt_pk_bf16_f32 v52, v40, v41
    v_exp_f32 v43, v43
    v_mfma_f32_32x32x16_bf16 v[56:71], v[80:83], v[48:51], v[56:71]
    ds_read_b128 v[80:83], v1 offset:51200
    v_exp_f32 v44, v44
    v_cvt_pk_bf16_f32 v53, v42, v43
    v_exp_f32 v45, v45
    v_exp_f32 v46, v46
    v_exp_f32 v47, v47
    v_cvt_pk_bf16_f32 v54, v44, v45
    v_cvt_pk_bf16_f32 v55, v46, v47
    s_setprio 1
    s_waitcnt lgkmcnt(2)
    v_mfma_f32_32x32x16_bf16 v[32:47], v[72:75], v[8:11], v[88:103]
    ds_read_b128 v[72:75], v1 offset:57344
    v_exp_f32 v16, v16
    v_exp_f32 v17, v17
    v_exp_f32 v18, v18
    v_cvt_pk_bf16_f32 v48, v16, v17
    v_exp_f32 v19, v19
    v_mfma_f32_32x32x16_bf16 v[56:71], v[84:87], v[52:55], v[56:71]
    ds_read_b128 v[84:87], v1 offset:52224
    v_exp_f32 v20, v20
    v_cvt_pk_bf16_f32 v49, v18, v19
    v_exp_f32 v21, v21
    v_exp_f32 v22, v22
    v_cvt_pk_bf16_f32 v50, v20, v21
    v_exp_f32 v23, v23
    s_waitcnt lgkmcnt(2)
    v_mfma_f32_32x32x16_bf16 v[32:47], v[76:79], v[12:15], v[32:47]
    ds_read_b128 v[76:79], v1 offset:58368
    v_exp_f32 v24, v24
    v_cvt_pk_bf16_f32 v51, v22, v23
    v_exp_f32 v25, v25
    v_exp_f32 v26, v26
    v_cvt_pk_bf16_f32 v52, v24, v25
    v_exp_f32 v27, v27
    v_mfma_f32_32x32x16_bf16 v[56:71], v[80:83], v[48:51], v[56:71]
    ds_read_b128 v[80:83], v1 offset:55296
    v_exp_f32 v28, v28
    v_cvt_pk_bf16_f32 v53, v26, v27
    v_exp_f32 v29, v29
    v_exp_f32 v30, v30
    v_exp_f32 v31, v31
    v_cvt_pk_bf16_f32 v54, v28, v29
    v_cvt_pk_bf16_f32 v55, v30, v31
    s_waitcnt lgkmcnt(2)
    v_mfma_f32_32x32x16_bf16 v[16:31], v[72:75], v[8:11], v[88:103]
    ds_read_b128 v[72:75], v1 offset:61440
    v_exp_f32 v32, v32
    v_exp_f32 v33, v33
    v_exp_f32 v34, v34
    v_cvt_pk_bf16_f32 v48, v32, v33
    v_exp_f32 v35, v35
    v_mfma_f32_32x32x16_bf16 v[56:71], v[84:87], v[52:55], v[56:71]
    ds_read_b128 v[84:87], v1 offset:56320
    v_exp_f32 v36, v36
    v_cvt_pk_bf16_f32 v49, v34, v35
    v_exp_f32 v37, v37
    v_exp_f32 v38, v38
    v_cvt_pk_bf16_f32 v50, v36, v37
    v_exp_f32 v39, v39
    s_waitcnt lgkmcnt(2)
    v_mfma_f32_32x32x16_bf16 v[16:31], v[76:79], v[12:15], v[16:31]
    ds_read_b128 v[76:79], v1 offset:62464
    v_exp_f32 v40, v40
    v_cvt_pk_bf16_f32 v51, v38, v39
    v_exp_f32 v41, v41
    v_exp_f32 v42, v42
    v_cvt_pk_bf16_f32 v52, v40, v41
    v_exp_f32 v43, v43
    v_mfma_f32_32x32x16_bf16 v[56:71], v[80:83], v[48:51], v[56:71]
    ds_read_b128 v[80:83], v1 offset:59392
    v_exp_f32 v44, v44
    v_cvt_pk_bf16_f32 v53, v42, v43
    v_exp_f32 v45, v45
    v_exp_f32 v46, v46
    v_exp_f32 v47, v47
    v_cvt_pk_bf16_f32 v54, v44, v45
    v_cvt_pk_bf16_f32 v55, v46, v47
    s_setprio 0
    s_waitcnt lgkmcnt(2)
    v_mfma_f32_32x32x16_bf16 v[32:47], v[72:75], v[8:11], v[88:103]
    ds_read_b128 v[72:75], v2
    v_exp_f32 v16, v16
    v_exp_f32 v17, v17
    v_exp_f32 v18, v18
    v_cvt_pk_bf16_f32 v48, v16, v17
    v_exp_f32 v19, v19
    v_mfma_f32_32x32x16_bf16 v[56:71], v[84:87], v[52:55], v[56:71]
    ds_read_b128 v[84:87], v1 offset:60416
    v_exp_f32 v20, v20
    v_cvt_pk_bf16_f32 v49, v18, v19
    v_exp_f32 v21, v21
    v_exp_f32 v22, v22
    v_cvt_pk_bf16_f32 v50, v20, v21
    v_exp_f32 v23, v23
    s_waitcnt lgkmcnt(2)
    v_mfma_f32_32x32x16_bf16 v[32:47], v[76:79], v[12:15], v[32:47]
    ds_read_b128 v[76:79], v2 offset:1024
    v_exp_f32 v24, v24
    v_cvt_pk_bf16_f32 v51, v22, v23
    v_exp_f32 v25, v25
    v_exp_f32 v26, v26
    v_cvt_pk_bf16_f32 v52, v24, v25
    v_exp_f32 v27, v27
    v_mfma_f32_32x32x16_bf16 v[56:71], v[80:83], v[48:51], v[56:71]
    ds_read_b128 v[80:83], v1 offset:63488
    v_exp_f32 v28, v28
    v_cvt_pk_bf16_f32 v53, v26, v27
    v_exp_f32 v29, v29
    v_exp_f32 v30, v30
    v_exp_f32 v31, v31
    v_cvt_pk_bf16_f32 v54, v28, v29
    v_cvt_pk_bf16_f32 v55, v30, v31
    s_waitcnt lgkmcnt(2)
    v_mfma_f32_32x32x16_bf16 v[16:31], v[72:75], v[8:11], v[88:103]
    ds_read_b128 v[72:75], v2 offset:4096
    v_exp_f32 v32, v32
    v_exp_f32 v33, v33
    v_exp_f32 v34, v34
    v_cvt_pk_bf16_f32 v48, v32, v33
    v_exp_f32 v35, v35
    v_mfma_f32_32x32x16_bf16 v[56:71], v[84:87], v[52:55], v[56:71]
    ds_read_b128 v[84:87], v1 offset:64512
    v_exp_f32 v36, v36
    v_cvt_pk_bf16_f32 v49, v34, v35
    v_exp_f32 v37, v37
    v_exp_f32 v38, v38
    v_cvt_pk_bf16_f32 v50, v36, v37
    v_exp_f32 v39, v39
    s_waitcnt lgkmcnt(2)
    v_mfma_f32_32x32x16_bf16 v[16:31], v[76:79], v[12:15], v[16:31]
    ds_read_b128 v[76:79], v2 offset:5120
    v_exp_f32 v40, v40
    v_cvt_pk_bf16_f32 v51, v38, v39
    v_exp_f32 v41, v41
    v_exp_f32 v42, v42
    v_cvt_pk_bf16_f32 v52, v40, v41
    v_exp_f32 v43, v43
    v_mfma_f32_32x32x16_bf16 v[56:71], v[80:83], v[48:51], v[56:71]
    ds_read_b128 v[80:83], v2 offset:2048
    v_exp_f32 v44, v44
    v_cvt_pk_bf16_f32 v53, v42, v43
    v_exp_f32 v45, v45
    v_exp_f32 v46, v46
    v_exp_f32 v47, v47
    v_cvt_pk_bf16_f32 v54, v44, v45
    v_cvt_pk_bf16_f32 v55, v46, v47
    s_waitcnt vmcnt(0) lgkmcnt(2)
    s_barrier
    s_setprio 3
    s_add_u32 m0, s48, 32768
    s_xor_b32 s51, s81, 131072
    v_mfma_f32_32x32x16_bf16 v[32:47], v[72:75], v[8:11], v[88:103]
    ds_read_b128 v[72:75], v2 offset:8192
    v_exp_f32 v16, v16
    v_exp_f32 v17, v17
    v_exp_f32 v18, v18
    v_cvt_pk_bf16_f32 v48, v16, v17
    v_exp_f32 v19, v19
    v_mfma_f32_32x32x16_bf16 v[56:71], v[84:87], v[52:55], v[56:71]
    ds_read_b128 v[84:87], v2 offset:3072
    buffer_load_dwordx4 v1, s[24:27], s51 offen sc1 lds
    v_exp_f32 v20, v20
    v_cvt_pk_bf16_f32 v49, v18, v19
    v_exp_f32 v21, v21
    v_exp_f32 v22, v22
    v_cvt_pk_bf16_f32 v50, v20, v21
    v_exp_f32 v23, v23
    s_waitcnt lgkmcnt(2)
    v_mfma_f32_32x32x16_bf16 v[32:47], v[76:79], v[12:15], v[32:47]
    ds_read_b128 v[76:79], v2 offset:9216
    v_exp_f32 v24, v24
    v_cvt_pk_bf16_f32 v51, v22, v23
    v_exp_f32 v25, v25
    v_exp_f32 v26, v26
    v_cvt_pk_bf16_f32 v52, v24, v25
    v_exp_f32 v27, v27
    v_mfma_f32_32x32x16_bf16 v[56:71], v[80:83], v[48:51], v[56:71]
    ds_read_b128 v[80:83], v2 offset:6144
    ds_read_b64_tr_b16 v[128:129], v6
    ds_read_b64_tr_b16 v[130:131], v6 offset:512
    ds_read_b64_tr_b16 v[132:133], v6 offset:1024
    ds_read_b64_tr_b16 v[134:135], v7 offset:1536
    v_exp_f32 v28, v28
    v_cvt_pk_bf16_f32 v53, v26, v27
    v_exp_f32 v29, v29
    v_exp_f32 v30, v30
    v_exp_f32 v31, v31
    v_cvt_pk_bf16_f32 v54, v28, v29
    v_cvt_pk_bf16_f32 v55, v30, v31
    s_waitcnt lgkmcnt(6)
    v_mfma_f32_32x32x16_bf16 v[16:31], v[72:75], v[8:11], v[88:103]
    ds_read_b128 v[72:75], v2 offset:12288
    v_exp_f32 v32, v32
    v_exp_f32 v33, v33
    v_exp_f32 v34, v34
    v_cvt_pk_bf16_f32 v48, v32, v33
    v_exp_f32 v35, v35
    v_mfma_f32_32x32x16_bf16 v[56:71], v[84:87], v[52:55], v[56:71]
    ds_read_b128 v[84:87], v2 offset:7168
    buffer_load_dwordx4 v1, s[24:27], s51 offen offset:1024 sc1 lds
    v_exp_f32 v36, v36
    v_cvt_pk_bf16_f32 v49, v34, v35
    v_exp_f32 v37, v37
    v_exp_f32 v38, v38
    v_cvt_pk_bf16_f32 v50, v36, v37
    v_exp_f32 v39, v39
    s_waitcnt lgkmcnt(6)
    v_mfma_f32_32x32x16_bf16 v[16:31], v[76:79], v[12:15], v[16:31]
    ds_read_b128 v[76:79], v2 offset:13312
    v_exp_f32 v40, v40
    v_cvt_pk_bf16_f32 v51, v38, v39
    v_exp_f32 v41, v41
    v_exp_f32 v42, v42
    v_cvt_pk_bf16_f32 v52, v40, v41
    v_exp_f32 v43, v43
    v_mfma_f32_32x32x16_bf16 v[56:71], v[80:83], v[48:51], v[56:71]
    ds_read_b128 v[80:83], v2 offset:10240
    ds_read_b64_tr_b16 v[136:137], v6 offset:1792
    ds_read_b64_tr_b16 v[138:139], v6 offset:2304
    ds_read_b64_tr_b16 v[140:141], v6 offset:2816
    ds_read_b64_tr_b16 v[142:143], v7 offset:3328
    v_exp_f32 v44, v44
    v_cvt_pk_bf16_f32 v53, v42, v43
    v_exp_f32 v45, v45
    v_exp_f32 v46, v46
    v_exp_f32 v47, v47
    v_cvt_pk_bf16_f32 v54, v44, v45
    v_cvt_pk_bf16_f32 v55, v46, v47
    s_setprio 2
    s_waitcnt lgkmcnt(6)
    v_mfma_f32_32x32x16_bf16 v[32:47], v[72:75], v[8:11], v[88:103]
    ds_read_b128 v[72:75], v2 offset:16384
    v_exp_f32 v16, v16
    v_exp_f32 v17, v17
    v_exp_f32 v18, v18
    v_cvt_pk_bf16_f32 v48, v16, v17
    v_exp_f32 v19, v19
    v_mfma_f32_32x32x16_bf16 v[56:71], v[84:87], v[52:55], v[56:71]
    ds_read_b128 v[84:87], v2 offset:11264
    buffer_load_dwordx4 v1, s[24:27], s51 offen offset:2048 sc1 lds
    v_exp_f32 v20, v20
    v_cvt_pk_bf16_f32 v49, v18, v19
    v_exp_f32 v21, v21
    v_exp_f32 v22, v22
    v_cvt_pk_bf16_f32 v50, v20, v21
    v_exp_f32 v23, v23
    s_waitcnt lgkmcnt(6)
    v_mfma_f32_32x32x16_bf16 v[32:47], v[76:79], v[12:15], v[32:47]
    ds_read_b128 v[76:79], v2 offset:17408
    v_exp_f32 v24, v24
    v_cvt_pk_bf16_f32 v51, v22, v23
    v_exp_f32 v25, v25
    v_exp_f32 v26, v26
    v_cvt_pk_bf16_f32 v52, v24, v25
    v_exp_f32 v27, v27
    v_mfma_f32_32x32x16_bf16 v[56:71], v[80:83], v[48:51], v[56:71]
    ds_read_b128 v[80:83], v2 offset:14336
    ds_read_b64_tr_b16 v[144:145], v6 offset:3584
    ds_read_b64_tr_b16 v[146:147], v6 offset:4096
    ds_read_b64_tr_b16 v[148:149], v6 offset:4608
    ds_read_b64_tr_b16 v[150:151], v7 offset:5120
    v_exp_f32 v28, v28
    v_cvt_pk_bf16_f32 v53, v26, v27
    v_exp_f32 v29, v29
    v_exp_f32 v30, v30
    v_exp_f32 v31, v31
    v_cvt_pk_bf16_f32 v54, v28, v29
    v_cvt_pk_bf16_f32 v55, v30, v31
    s_waitcnt lgkmcnt(6)
    v_mfma_f32_32x32x16_bf16 v[16:31], v[72:75], v[8:11], v[88:103]
    ds_read_b128 v[72:75], v2 offset:20480
    v_exp_f32 v32, v32
    v_exp_f32 v33, v33
    v_exp_f32 v34, v34
    v_cvt_pk_bf16_f32 v48, v32, v33
    v_exp_f32 v35, v35
    v_mfma_f32_32x32x16_bf16 v[56:71], v[84:87], v[52:55], v[56:71]
    ds_read_b128 v[84:87], v2 offset:15360
    buffer_load_dwordx4 v1, s[24:27], s51 offen offset:3072 sc1 lds
    v_exp_f32 v36, v36
    v_cvt_pk_bf16_f32 v49, v34, v35
    v_exp_f32 v37, v37
    v_exp_f32 v38, v38
    v_cvt_pk_bf16_f32 v50, v36, v37
    v_exp_f32 v39, v39
    s_waitcnt lgkmcnt(6)
    v_mfma_f32_32x32x16_bf16 v[16:31], v[76:79], v[12:15], v[16:31]
    ds_read_b128 v[76:79], v2 offset:21504
    v_exp_f32 v40, v40
    v_cvt_pk_bf16_f32 v51, v38, v39
    v_exp_f32 v41, v41
    v_exp_f32 v42, v42
    v_cvt_pk_bf16_f32 v52, v40, v41
    v_exp_f32 v43, v43
    v_mfma_f32_32x32x16_bf16 v[56:71], v[80:83], v[48:51], v[56:71]
    ds_read_b128 v[80:83], v2 offset:18432
    ds_read_b64_tr_b16 v[152:153], v6 offset:5376
    ds_read_b64_tr_b16 v[154:155], v6 offset:5888
    ds_read_b64_tr_b16 v[156:157], v6 offset:6400
    ds_read_b64_tr_b16 v[158:159], v7 offset:6912
    v_exp_f32 v44, v44
    v_cvt_pk_bf16_f32 v53, v42, v43
    v_exp_f32 v45, v45
    v_exp_f32 v46, v46
    v_exp_f32 v47, v47
    v_cvt_pk_bf16_f32 v54, v44, v45
    v_cvt_pk_bf16_f32 v55, v46, v47
    s_setprio 1
    s_waitcnt lgkmcnt(6)
    v_mfma_f32_32x32x16_bf16 v[32:47], v[72:75], v[8:11], v[88:103]
    ds_read_b128 v[72:75], v2 offset:24576
    v_exp_f32 v16, v16
    v_exp_f32 v17, v17
    v_exp_f32 v18, v18
    v_cvt_pk_bf16_f32 v48, v16, v17
    v_exp_f32 v19, v19
    v_mfma_f32_32x32x16_bf16 v[56:71], v[84:87], v[52:55], v[56:71]
    ds_read_b128 v[84:87], v2 offset:19456
    s_waitcnt lgkmcnt(2)
    s_add_u32 m0, s49, 0
    s_add_u32 s52, s67, 256
    v_exp_f32 v20, v20
    buffer_load_dwordx4 v111, s[28:31], s52 offen lds
    v_cvt_pk_bf16_f32 v49, v18, v19
    v_exp_f32 v21, v21
    v_exp_f32 v22, v22
    v_cvt_pk_bf16_f32 v50, v20, v21
    v_exp_f32 v23, v23
    v_mfma_f32_32x32x16_bf16 v[32:47], v[76:79], v[12:15], v[32:47]
    ds_read_b128 v[76:79], v2 offset:25600
    s_add_u32 m0, s49, 1024
    s_add_u32 s52, s67, 14592
    v_exp_f32 v24, v24
    buffer_load_dwordx4 v111, s[28:31], s52 offen lds
    v_cvt_pk_bf16_f32 v51, v22, v23
    v_exp_f32 v25, v25
    v_exp_f32 v26, v26
    v_cvt_pk_bf16_f32 v52, v24, v25
    v_exp_f32 v27, v27
    v_mfma_f32_32x32x16_bf16 v[56:71], v[80:83], v[48:51], v[56:71]
    ds_read_b128 v[80:83], v2 offset:22528
    v_exp_f32 v28, v28
    v_cvt_pk_bf16_f32 v53, v26, v27
    v_exp_f32 v29, v29
    v_exp_f32 v30, v30
    v_exp_f32 v31, v31
    v_cvt_pk_bf16_f32 v54, v28, v29
    v_cvt_pk_bf16_f32 v55, v30, v31
    s_waitcnt lgkmcnt(2)
    v_mfma_f32_32x32x16_bf16 v[16:31], v[72:75], v[8:11], v[88:103]
    ds_read_b128 v[72:75], v2 offset:28672
    v_exp_f32 v32, v32
    v_exp_f32 v33, v33
    v_exp_f32 v34, v34
    v_cvt_pk_bf16_f32 v48, v32, v33
    v_exp_f32 v35, v35
    v_mfma_f32_32x32x16_bf16 v[56:71], v[84:87], v[52:55], v[56:71]
    ds_read_b128 v[84:87], v2 offset:23552
    s_add_u32 m0, s49, 2048
    s_add_u32 s52, s67, 28928
    v_exp_f32 v36, v36
    buffer_load_dwordx4 v111, s[28:31], s52 offen lds
    v_cvt_pk_bf16_f32 v49, v34, v35
    v_exp_f32 v37, v37
    v_exp_f32 v38, v38
    v_cvt_pk_bf16_f32 v50, v36, v37
    v_exp_f32 v39, v39
    s_waitcnt lgkmcnt(2)
    v_mfma_f32_32x32x16_bf16 v[16:31], v[76:79], v[12:15], v[16:31]
    ds_read_b128 v[76:79], v2 offset:29696
    s_add_u32 m0, s49, 3072
    s_add_u32 s52, s67, 43264
    v_exp_f32 v40, v40
    buffer_load_dwordx4 v111, s[28:31], s52 offen lds
    v_cvt_pk_bf16_f32 v51, v38, v39
    v_exp_f32 v41, v41
    v_exp_f32 v42, v42
    v_cvt_pk_bf16_f32 v52, v40, v41
    v_exp_f32 v43, v43
    v_mfma_f32_32x32x16_bf16 v[56:71], v[80:83], v[48:51], v[56:71]
    ds_read_b128 v[80:83], v2 offset:26624
    v_exp_f32 v44, v44
    v_cvt_pk_bf16_f32 v53, v42, v43
    v_exp_f32 v45, v45
    v_exp_f32 v46, v46
    v_exp_f32 v47, v47
    v_cvt_pk_bf16_f32 v54, v44, v45
    v_cvt_pk_bf16_f32 v55, v46, v47
    s_setprio 0
    s_waitcnt lgkmcnt(2)
    v_mfma_f32_32x32x16_bf16 v[32:47], v[72:75], v[8:11], v[88:103]
    ds_read_b128 v[72:75], v1
    v_exp_f32 v16, v16
    v_exp_f32 v17, v17
    v_exp_f32 v18, v18
    v_cvt_pk_bf16_f32 v48, v16, v17
    v_exp_f32 v19, v19
    v_mfma_f32_32x32x16_bf16 v[56:71], v[84:87], v[52:55], v[56:71]
    ds_read_b128 v[84:87], v2 offset:27648
    s_add_u32 m0, s49, 4096
    s_add_u32 s52, s67, 57600
    v_exp_f32 v20, v20
    buffer_load_dwordx4 v111, s[28:31], s52 offen lds
    v_cvt_pk_bf16_f32 v49, v18, v19
    v_exp_f32 v21, v21
    v_exp_f32 v22, v22
    v_cvt_pk_bf16_f32 v50, v20, v21
    v_exp_f32 v23, v23
    s_waitcnt lgkmcnt(2)
    v_mfma_f32_32x32x16_bf16 v[32:47], v[76:79], v[12:15], v[32:47]
    ds_read_b128 v[76:79], v1 offset:1024
    s_add_u32 m0, s49, 5120
    s_add_u32 s52, s67, 71936
    v_exp_f32 v24, v24
    buffer_load_dwordx4 v111, s[28:31], s52 offen lds
    v_cvt_pk_bf16_f32 v51, v22, v23
    v_exp_f32 v25, v25
    v_exp_f32 v26, v26
    v_cvt_pk_bf16_f32 v52, v24, v25
    v_exp_f32 v27, v27
    v_mfma_f32_32x32x16_bf16 v[56:71], v[80:83], v[48:51], v[56:71]
    ds_read_b128 v[80:83], v2 offset:30720
    v_exp_f32 v28, v28
    v_cvt_pk_bf16_f32 v53, v26, v27
    v_exp_f32 v29, v29
    v_exp_f32 v30, v30
    v_exp_f32 v31, v31
    v_cvt_pk_bf16_f32 v54, v28, v29
    v_cvt_pk_bf16_f32 v55, v30, v31
    s_waitcnt lgkmcnt(2)
    v_mfma_f32_32x32x16_bf16 v[16:31], v[72:75], v[8:11], v[88:103]
    ds_read_b128 v[72:75], v1 offset:4096
    v_exp_f32 v32, v32
    v_exp_f32 v33, v33
    v_exp_f32 v34, v34
    v_cvt_pk_bf16_f32 v48, v32, v33
    v_exp_f32 v35, v35
    v_mfma_f32_32x32x16_bf16 v[56:71], v[84:87], v[52:55], v[56:71]
    ds_read_b128 v[84:87], v2 offset:31744
    s_add_u32 m0, s49, 6144
    s_add_u32 s52, s67, 86272
    v_exp_f32 v36, v36
    buffer_load_dwordx4 v111, s[28:31], s52 offen lds
    v_cvt_pk_bf16_f32 v49, v34, v35
    v_exp_f32 v37, v37
    v_exp_f32 v38, v38
    v_cvt_pk_bf16_f32 v50, v36, v37
    v_exp_f32 v39, v39
    s_waitcnt lgkmcnt(2)
    v_mfma_f32_32x32x16_bf16 v[16:31], v[76:79], v[12:15], v[16:31]
    ds_read_b128 v[76:79], v1 offset:5120
    v_exp_f32 v40, v40
    v_cvt_pk_bf16_f32 v51, v38, v39
    v_exp_f32 v41, v41
    v_exp_f32 v42, v42
    v_cvt_pk_bf16_f32 v52, v40, v41
    v_exp_f32 v43, v43
    v_mfma_f32_32x32x16_bf16 v[56:71], v[80:83], v[48:51], v[56:71]
    ds_read_b128 v[80:83], v1 offset:2048
    v_exp_f32 v44, v44
    v_cvt_pk_bf16_f32 v53, v42, v43
    v_exp_f32 v45, v45
    v_exp_f32 v46, v46
    v_exp_f32 v47, v47
    v_cvt_pk_bf16_f32 v54, v44, v45
    v_cvt_pk_bf16_f32 v55, v46, v47
    s_waitcnt vmcnt(7) lgkmcnt(2)
    s_barrier
    s_setprio 3
    s_add_u32 m0, s48, 65536
    s_xor_b32 s51, s81, 163840
    v_mfma_f32_32x32x16_bf16 v[32:47], v[72:75], v[8:11], v[88:103]
    ds_read_b128 v[72:75], v1 offset:8192
    v_exp_f32 v16, v16
    v_exp_f32 v17, v17
    v_exp_f32 v18, v18
    v_cvt_pk_bf16_f32 v48, v16, v17
    v_exp_f32 v19, v19
    v_mfma_f32_32x32x16_bf16 v[56:71], v[84:87], v[52:55], v[56:71]
    ds_read_b128 v[84:87], v1 offset:3072
    buffer_load_dwordx4 v1, s[24:27], s51 offen sc1 lds
    v_exp_f32 v20, v20
    v_cvt_pk_bf16_f32 v49, v18, v19
    v_exp_f32 v21, v21
    v_exp_f32 v22, v22
    v_cvt_pk_bf16_f32 v50, v20, v21
    v_exp_f32 v23, v23
    s_waitcnt lgkmcnt(2)
    v_mfma_f32_32x32x16_bf16 v[32:47], v[76:79], v[12:15], v[32:47]
    ds_read_b128 v[76:79], v1 offset:9216
    v_exp_f32 v24, v24
    v_cvt_pk_bf16_f32 v51, v22, v23
    v_exp_f32 v25, v25
    v_exp_f32 v26, v26
    v_cvt_pk_bf16_f32 v52, v24, v25
    v_exp_f32 v27, v27
    v_mfma_f32_32x32x16_bf16 v[56:71], v[80:83], v[48:51], v[56:71]
    ds_read_b128 v[80:83], v1 offset:6144
    v_exp_f32 v28, v28
    v_cvt_pk_bf16_f32 v53, v26, v27
    v_exp_f32 v29, v29
    v_exp_f32 v30, v30
    v_exp_f32 v31, v31
    v_cvt_pk_bf16_f32 v54, v28, v29
    v_cvt_pk_bf16_f32 v55, v30, v31
    s_waitcnt lgkmcnt(2)
    v_mfma_f32_32x32x16_bf16 v[16:31], v[72:75], v[8:11], v[88:103]
    ds_read_b128 v[72:75], v1 offset:12288
    v_exp_f32 v32, v32
    v_exp_f32 v33, v33
    v_exp_f32 v34, v34
    v_cvt_pk_bf16_f32 v48, v32, v33
    v_exp_f32 v35, v35
    v_mfma_f32_32x32x16_bf16 v[56:71], v[84:87], v[52:55], v[56:71]
    ds_read_b128 v[84:87], v1 offset:7168
    buffer_load_dwordx4 v1, s[24:27], s51 offen offset:1024 sc1 lds
    v_exp_f32 v36, v36
    v_cvt_pk_bf16_f32 v49, v34, v35
    v_exp_f32 v37, v37
    v_exp_f32 v38, v38
    v_cvt_pk_bf16_f32 v50, v36, v37
    v_exp_f32 v39, v39
    s_waitcnt lgkmcnt(2)
    v_mfma_f32_32x32x16_bf16 v[16:31], v[76:79], v[12:15], v[16:31]
    ds_read_b128 v[76:79], v1 offset:13312
    v_exp_f32 v40, v40
    v_cvt_pk_bf16_f32 v51, v38, v39
    v_exp_f32 v41, v41
    v_exp_f32 v42, v42
    v_cvt_pk_bf16_f32 v52, v40, v41
    v_exp_f32 v43, v43
    v_mfma_f32_32x32x16_bf16 v[56:71], v[80:83], v[48:51], v[56:71]
    ds_read_b128 v[80:83], v1 offset:10240
    v_exp_f32 v44, v44
    v_cvt_pk_bf16_f32 v53, v42, v43
    v_exp_f32 v45, v45
    v_exp_f32 v46, v46
    v_exp_f32 v47, v47
    v_cvt_pk_bf16_f32 v54, v44, v45
    v_cvt_pk_bf16_f32 v55, v46, v47
    s_setprio 2
    s_waitcnt lgkmcnt(2)
    v_mfma_f32_32x32x16_bf16 v[32:47], v[72:75], v[8:11], v[88:103]
    ds_read_b128 v[72:75], v1 offset:16384
    v_exp_f32 v16, v16
    v_exp_f32 v17, v17
    v_exp_f32 v18, v18
    v_cvt_pk_bf16_f32 v48, v16, v17
    v_exp_f32 v19, v19
    v_mfma_f32_32x32x16_bf16 v[56:71], v[84:87], v[52:55], v[56:71]
    ds_read_b128 v[84:87], v1 offset:11264
    buffer_load_dwordx4 v1, s[24:27], s51 offen offset:2048 sc1 lds
    v_exp_f32 v20, v20
    v_cvt_pk_bf16_f32 v49, v18, v19
    v_exp_f32 v21, v21
    v_exp_f32 v22, v22
    v_cvt_pk_bf16_f32 v50, v20, v21
    v_exp_f32 v23, v23
    s_waitcnt lgkmcnt(2)
    v_mfma_f32_32x32x16_bf16 v[32:47], v[76:79], v[12:15], v[32:47]
    ds_read_b128 v[76:79], v1 offset:17408
    v_exp_f32 v24, v24
    v_cvt_pk_bf16_f32 v51, v22, v23
    v_exp_f32 v25, v25
    v_exp_f32 v26, v26
    v_cvt_pk_bf16_f32 v52, v24, v25
    v_exp_f32 v27, v27
    v_mfma_f32_32x32x16_bf16 v[56:71], v[80:83], v[48:51], v[56:71]
    ds_read_b128 v[80:83], v1 offset:14336
    v_exp_f32 v28, v28
    v_cvt_pk_bf16_f32 v53, v26, v27
    v_exp_f32 v29, v29
    v_exp_f32 v30, v30
    v_exp_f32 v31, v31
    v_cvt_pk_bf16_f32 v54, v28, v29
    v_cvt_pk_bf16_f32 v55, v30, v31
    s_waitcnt lgkmcnt(2)
    v_mfma_f32_32x32x16_bf16 v[16:31], v[72:75], v[8:11], v[88:103]
    ds_read_b128 v[72:75], v1 offset:20480
    v_exp_f32 v32, v32
    v_exp_f32 v33, v33
    v_exp_f32 v34, v34
    v_cvt_pk_bf16_f32 v48, v32, v33
    v_exp_f32 v35, v35
    v_mfma_f32_32x32x16_bf16 v[56:71], v[84:87], v[52:55], v[56:71]
    ds_read_b128 v[84:87], v1 offset:15360
    buffer_load_dwordx4 v1, s[24:27], s51 offen offset:3072 sc1 lds
    v_exp_f32 v36, v36
    v_cvt_pk_bf16_f32 v49, v34, v35
    v_exp_f32 v37, v37
    v_exp_f32 v38, v38
    v_cvt_pk_bf16_f32 v50, v36, v37
    v_exp_f32 v39, v39
    s_waitcnt lgkmcnt(2)
    v_mfma_f32_32x32x16_bf16 v[16:31], v[76:79], v[12:15], v[16:31]
    ds_read_b128 v[76:79], v1 offset:21504
    v_exp_f32 v40, v40
    v_cvt_pk_bf16_f32 v51, v38, v39
    v_exp_f32 v41, v41
    v_exp_f32 v42, v42
    v_cvt_pk_bf16_f32 v52, v40, v41
    v_exp_f32 v43, v43
    v_mfma_f32_32x32x16_bf16 v[56:71], v[80:83], v[48:51], v[56:71]
    ds_read_b128 v[80:83], v1 offset:18432
    v_exp_f32 v44, v44
    v_cvt_pk_bf16_f32 v53, v42, v43
    v_exp_f32 v45, v45
    v_exp_f32 v46, v46
    v_exp_f32 v47, v47
    v_cvt_pk_bf16_f32 v54, v44, v45
    v_cvt_pk_bf16_f32 v55, v46, v47
    s_setprio 1
    s_waitcnt lgkmcnt(2)
    v_mfma_f32_32x32x16_bf16 v[32:47], v[72:75], v[8:11], v[88:103]
    ds_read_b128 v[72:75], v1 offset:24576
    v_exp_f32 v16, v16
    v_exp_f32 v17, v17
    v_exp_f32 v18, v18
    v_cvt_pk_bf16_f32 v48, v16, v17
    v_exp_f32 v19, v19
    v_mfma_f32_32x32x16_bf16 v[56:71], v[84:87], v[52:55], v[56:71]
    ds_read_b128 v[84:87], v1 offset:19456
    v_exp_f32 v20, v20
    v_cvt_pk_bf16_f32 v49, v18, v19
    v_exp_f32 v21, v21
    v_exp_f32 v22, v22
    v_cvt_pk_bf16_f32 v50, v20, v21
    v_exp_f32 v23, v23
    s_waitcnt lgkmcnt(2)
    v_mfma_f32_32x32x16_bf16 v[32:47], v[76:79], v[12:15], v[32:47]
    ds_read_b128 v[76:79], v1 offset:25600
    v_exp_f32 v24, v24
    v_cvt_pk_bf16_f32 v51, v22, v23
    v_exp_f32 v25, v25
    v_exp_f32 v26, v26
    v_cvt_pk_bf16_f32 v52, v24, v25
    v_exp_f32 v27, v27
    v_mfma_f32_32x32x16_bf16 v[56:71], v[80:83], v[48:51], v[56:71]
    ds_read_b128 v[80:83], v1 offset:22528
    v_exp_f32 v28, v28
    v_cvt_pk_bf16_f32 v53, v26, v27
    v_exp_f32 v29, v29
    v_exp_f32 v30, v30
    v_exp_f32 v31, v31
    v_cvt_pk_bf16_f32 v54, v28, v29
    v_cvt_pk_bf16_f32 v55, v30, v31
    s_waitcnt lgkmcnt(2)
    v_mfma_f32_32x32x16_bf16 v[16:31], v[72:75], v[8:11], v[88:103]
    ds_read_b128 v[72:75], v1 offset:28672
    v_exp_f32 v32, v32
    v_exp_f32 v33, v33
    v_exp_f32 v34, v34
    v_cvt_pk_bf16_f32 v48, v32, v33
    v_exp_f32 v35, v35
    v_mfma_f32_32x32x16_bf16 v[56:71], v[84:87], v[52:55], v[56:71]
    ds_read_b128 v[84:87], v1 offset:23552
    v_exp_f32 v36, v36
    v_cvt_pk_bf16_f32 v49, v34, v35
    v_exp_f32 v37, v37
    v_exp_f32 v38, v38
    v_cvt_pk_bf16_f32 v50, v36, v37
    v_exp_f32 v39, v39
    s_waitcnt lgkmcnt(2)
    v_mfma_f32_32x32x16_bf16 v[16:31], v[76:79], v[12:15], v[16:31]
    ds_read_b128 v[76:79], v1 offset:29696
    v_exp_f32 v40, v40
    v_cvt_pk_bf16_f32 v51, v38, v39
    v_exp_f32 v41, v41
    v_exp_f32 v42, v42
    v_cvt_pk_bf16_f32 v52, v40, v41
    v_exp_f32 v43, v43
    v_mfma_f32_32x32x16_bf16 v[56:71], v[80:83], v[48:51], v[56:71]
    ds_read_b128 v[80:83], v1 offset:26624
    v_exp_f32 v44, v44
    v_cvt_pk_bf16_f32 v53, v42, v43
    v_exp_f32 v45, v45
    v_exp_f32 v46, v46
    v_exp_f32 v47, v47
    v_cvt_pk_bf16_f32 v54, v44, v45
    v_cvt_pk_bf16_f32 v55, v46, v47
    s_setprio 0
    s_waitcnt lgkmcnt(2)
    v_mfma_f32_32x32x16_bf16 v[32:47], v[72:75], v[8:11], v[88:103]
    ds_read_b128 v[72:75], v1 offset:32768
    v_exp_f32 v16, v16
    v_exp_f32 v17, v17
    v_exp_f32 v18, v18
    v_cvt_pk_bf16_f32 v48, v16, v17
    v_exp_f32 v19, v19
    v_mfma_f32_32x32x16_bf16 v[56:71], v[84:87], v[52:55], v[56:71]
    ds_read_b128 v[84:87], v1 offset:27648
    v_exp_f32 v20, v20
    v_cvt_pk_bf16_f32 v49, v18, v19
    v_exp_f32 v21, v21
    v_exp_f32 v22, v22
    v_cvt_pk_bf16_f32 v50, v20, v21
    v_exp_f32 v23, v23
    s_waitcnt lgkmcnt(2)
    v_mfma_f32_32x32x16_bf16 v[32:47], v[76:79], v[12:15], v[32:47]
    ds_read_b128 v[76:79], v1 offset:33792
    v_exp_f32 v24, v24
    v_cvt_pk_bf16_f32 v51, v22, v23
    v_exp_f32 v25, v25
    v_exp_f32 v26, v26
    v_cvt_pk_bf16_f32 v52, v24, v25
    v_exp_f32 v27, v27
    v_mfma_f32_32x32x16_bf16 v[56:71], v[80:83], v[48:51], v[56:71]
    ds_read_b128 v[80:83], v1 offset:30720
    v_exp_f32 v28, v28
    v_cvt_pk_bf16_f32 v53, v26, v27
    v_exp_f32 v29, v29
    v_exp_f32 v30, v30
    v_exp_f32 v31, v31
    v_cvt_pk_bf16_f32 v54, v28, v29
    v_cvt_pk_bf16_f32 v55, v30, v31
    s_waitcnt lgkmcnt(2)
    v_mfma_f32_32x32x16_bf16 v[16:31], v[72:75], v[8:11], v[88:103]
    ds_read_b128 v[72:75], v1 offset:36864
    v_exp_f32 v32, v32
    v_exp_f32 v33, v33
    v_exp_f32 v34, v34
    v_cvt_pk_bf16_f32 v48, v32, v33
    v_exp_f32 v35, v35
    v_mfma_f32_32x32x16_bf16 v[56:71], v[84:87], v[52:55], v[56:71]
    ds_read_b128 v[84:87], v1 offset:31744
    v_exp_f32 v36, v36
    v_cvt_pk_bf16_f32 v49, v34, v35
    v_exp_f32 v37, v37
    v_exp_f32 v38, v38
    v_cvt_pk_bf16_f32 v50, v36, v37
    v_exp_f32 v39, v39
    s_waitcnt lgkmcnt(2)
    v_mfma_f32_32x32x16_bf16 v[16:31], v[76:79], v[12:15], v[16:31]
    ds_read_b128 v[76:79], v1 offset:37888
    v_exp_f32 v40, v40
    v_cvt_pk_bf16_f32 v51, v38, v39
    v_exp_f32 v41, v41
    v_exp_f32 v42, v42
    v_cvt_pk_bf16_f32 v52, v40, v41
    v_exp_f32 v43, v43
    v_mfma_f32_32x32x16_bf16 v[56:71], v[80:83], v[48:51], v[56:71]
    ds_read_b128 v[80:83], v1 offset:34816
    v_exp_f32 v44, v44
    v_cvt_pk_bf16_f32 v53, v42, v43
    v_exp_f32 v45, v45
    v_exp_f32 v46, v46
    v_exp_f32 v47, v47
    v_cvt_pk_bf16_f32 v54, v44, v45
    v_cvt_pk_bf16_f32 v55, v46, v47
    s_waitcnt vmcnt(0) lgkmcnt(2)
    s_barrier
    s_setprio 3
    s_add_u32 m0, s48, 0
    s_xor_b32 s51, s81, 196608
    v_mfma_f32_32x32x16_bf16 v[32:47], v[72:75], v[8:11], v[88:103]
    ds_read_b128 v[72:75], v1 offset:40960
    v_exp_f32 v16, v16
    v_exp_f32 v17, v17
    v_exp_f32 v18, v18
    v_cvt_pk_bf16_f32 v48, v16, v17
    v_exp_f32 v19, v19
    v_mfma_f32_32x32x16_bf16 v[56:71], v[84:87], v[52:55], v[56:71]
    ds_read_b128 v[84:87], v1 offset:35840
    buffer_load_dwordx4 v1, s[24:27], s51 offen sc1 lds
    v_exp_f32 v20, v20
    v_cvt_pk_bf16_f32 v49, v18, v19
    v_exp_f32 v21, v21
    v_exp_f32 v22, v22
    v_cvt_pk_bf16_f32 v50, v20, v21
    v_exp_f32 v23, v23
    s_waitcnt lgkmcnt(2)
    v_mfma_f32_32x32x16_bf16 v[32:47], v[76:79], v[12:15], v[32:47]
    ds_read_b128 v[76:79], v1 offset:41984
    v_exp_f32 v24, v24
    v_cvt_pk_bf16_f32 v51, v22, v23
    v_exp_f32 v25, v25
    v_exp_f32 v26, v26
    v_cvt_pk_bf16_f32 v52, v24, v25
    v_exp_f32 v27, v27
    v_mfma_f32_32x32x16_bf16 v[56:71], v[80:83], v[48:51], v[56:71]
    ds_read_b128 v[80:83], v1 offset:38912
    ds_read_b64_tr_b16 v[160:161], v6
    ds_read_b64_tr_b16 v[162:163], v6 offset:512
    ds_read_b64_tr_b16 v[164:165], v6 offset:1024
    ds_read_b64_tr_b16 v[166:167], v7 offset:1536
    v_exp_f32 v28, v28
    v_cvt_pk_bf16_f32 v53, v26, v27
    v_exp_f32 v29, v29
    v_exp_f32 v30, v30
    v_exp_f32 v31, v31
    v_cvt_pk_bf16_f32 v54, v28, v29
    v_cvt_pk_bf16_f32 v55, v30, v31
    s_waitcnt lgkmcnt(6)
    v_mfma_f32_32x32x16_bf16 v[16:31], v[72:75], v[8:11], v[88:103]
    ds_read_b128 v[72:75], v1 offset:45056
    v_exp_f32 v32, v32
    v_exp_f32 v33, v33
    v_exp_f32 v34, v34
    v_cvt_pk_bf16_f32 v48, v32, v33
    v_exp_f32 v35, v35
    v_mfma_f32_32x32x16_bf16 v[56:71], v[84:87], v[52:55], v[56:71]
    ds_read_b128 v[84:87], v1 offset:39936
    buffer_load_dwordx4 v1, s[24:27], s51 offen offset:1024 sc1 lds
    v_exp_f32 v36, v36
    v_cvt_pk_bf16_f32 v49, v34, v35
    v_exp_f32 v37, v37
    v_exp_f32 v38, v38
    v_cvt_pk_bf16_f32 v50, v36, v37
    v_exp_f32 v39, v39
    s_waitcnt lgkmcnt(6)
    v_mfma_f32_32x32x16_bf16 v[16:31], v[76:79], v[12:15], v[16:31]
    ds_read_b128 v[76:79], v1 offset:46080
    v_exp_f32 v40, v40
    v_cvt_pk_bf16_f32 v51, v38, v39
    v_exp_f32 v41, v41
    v_exp_f32 v42, v42
    v_cvt_pk_bf16_f32 v52, v40, v41
    v_exp_f32 v43, v43
    v_mfma_f32_32x32x16_bf16 v[56:71], v[80:83], v[48:51], v[56:71]
    ds_read_b128 v[80:83], v1 offset:43008
    ds_read_b64_tr_b16 v[168:169], v6 offset:1792
    ds_read_b64_tr_b16 v[170:171], v6 offset:2304
    ds_read_b64_tr_b16 v[172:173], v6 offset:2816
    ds_read_b64_tr_b16 v[174:175], v7 offset:3328
    v_exp_f32 v44, v44
    v_cvt_pk_bf16_f32 v53, v42, v43
    v_exp_f32 v45, v45
    v_exp_f32 v46, v46
    v_exp_f32 v47, v47
    v_cvt_pk_bf16_f32 v54, v44, v45
    v_cvt_pk_bf16_f32 v55, v46, v47
    s_setprio 2
    s_waitcnt lgkmcnt(6)
    v_mfma_f32_32x32x16_bf16 v[32:47], v[72:75], v[8:11], v[88:103]
    ds_read_b128 v[72:75], v1 offset:49152
    v_exp_f32 v16, v16
    v_exp_f32 v17, v17
    v_exp_f32 v18, v18
    v_cvt_pk_bf16_f32 v48, v16, v17
    v_exp_f32 v19, v19
    v_mfma_f32_32x32x16_bf16 v[56:71], v[84:87], v[52:55], v[56:71]
    ds_read_b128 v[84:87], v1 offset:44032
    buffer_load_dwordx4 v1, s[24:27], s51 offen offset:2048 sc1 lds
    v_exp_f32 v20, v20
    v_cvt_pk_bf16_f32 v49, v18, v19
    v_exp_f32 v21, v21
    v_exp_f32 v22, v22
    v_cvt_pk_bf16_f32 v50, v20, v21
    v_exp_f32 v23, v23
    s_waitcnt lgkmcnt(6)
    v_mfma_f32_32x32x16_bf16 v[32:47], v[76:79], v[12:15], v[32:47]
    ds_read_b128 v[76:79], v1 offset:50176
    v_exp_f32 v24, v24
    v_cvt_pk_bf16_f32 v51, v22, v23
    v_exp_f32 v25, v25
    v_exp_f32 v26, v26
    v_cvt_pk_bf16_f32 v52, v24, v25
    v_exp_f32 v27, v27
    v_mfma_f32_32x32x16_bf16 v[56:71], v[80:83], v[48:51], v[56:71]
    ds_read_b128 v[80:83], v1 offset:47104
    ds_read_b64_tr_b16 v[176:177], v6 offset:3584
    ds_read_b64_tr_b16 v[178:179], v6 offset:4096
    ds_read_b64_tr_b16 v[180:181], v6 offset:4608
    ds_read_b64_tr_b16 v[182:183], v7 offset:5120
    v_exp_f32 v28, v28
    v_cvt_pk_bf16_f32 v53, v26, v27
    v_exp_f32 v29, v29
    v_exp_f32 v30, v30
    v_exp_f32 v31, v31
    v_cvt_pk_bf16_f32 v54, v28, v29
    v_cvt_pk_bf16_f32 v55, v30, v31
    s_waitcnt lgkmcnt(6)
    v_mfma_f32_32x32x16_bf16 v[16:31], v[72:75], v[8:11], v[88:103]
    ds_read_b128 v[72:75], v1 offset:53248
    v_exp_f32 v32, v32
    v_exp_f32 v33, v33
    v_exp_f32 v34, v34
    v_cvt_pk_bf16_f32 v48, v32, v33
    v_exp_f32 v35, v35
    v_mfma_f32_32x32x16_bf16 v[56:71], v[84:87], v[52:55], v[56:71]
    ds_read_b128 v[84:87], v1 offset:48128
    buffer_load_dwordx4 v1, s[24:27], s51 offen offset:3072 sc1 lds
    v_exp_f32 v36, v36
    v_cvt_pk_bf16_f32 v49, v34, v35
    v_exp_f32 v37, v37
    v_exp_f32 v38, v38
    v_cvt_pk_bf16_f32 v50, v36, v37
    v_exp_f32 v39, v39
    s_waitcnt lgkmcnt(6)
    v_mfma_f32_32x32x16_bf16 v[16:31], v[76:79], v[12:15], v[16:31]
    ds_read_b128 v[76:79], v1 offset:54272
    v_exp_f32 v40, v40
    v_cvt_pk_bf16_f32 v51, v38, v39
    v_exp_f32 v41, v41
    v_exp_f32 v42, v42
    v_cvt_pk_bf16_f32 v52, v40, v41
    v_exp_f32 v43, v43
    v_mfma_f32_32x32x16_bf16 v[56:71], v[80:83], v[48:51], v[56:71]
    ds_read_b128 v[80:83], v1 offset:51200
    ds_read_b64_tr_b16 v[184:185], v6 offset:5376
    ds_read_b64_tr_b16 v[186:187], v6 offset:5888
    ds_read_b64_tr_b16 v[188:189], v6 offset:6400
    ds_read_b64_tr_b16 v[190:191], v7 offset:6912
    v_exp_f32 v44, v44
    v_cvt_pk_bf16_f32 v53, v42, v43
    v_exp_f32 v45, v45
    v_exp_f32 v46, v46
    v_exp_f32 v47, v47
    v_cvt_pk_bf16_f32 v54, v44, v45
    v_cvt_pk_bf16_f32 v55, v46, v47
    s_setprio 1
    s_waitcnt lgkmcnt(6)
    v_mfma_f32_32x32x16_bf16 v[32:47], v[72:75], v[8:11], v[88:103]
    ds_read_b128 v[72:75], v1 offset:57344
    v_exp_f32 v16, v16
    v_exp_f32 v17, v17
    v_exp_f32 v18, v18
    v_cvt_pk_bf16_f32 v48, v16, v17
    v_exp_f32 v19, v19
    v_mfma_f32_32x32x16_bf16 v[56:71], v[84:87], v[52:55], v[56:71]
    ds_read_b128 v[84:87], v1 offset:52224
    s_waitcnt lgkmcnt(2)
    s_add_u32 m0, s49, 0
    s_add_u32 s52, s68, 256
    v_exp_f32 v20, v20
    buffer_load_dwordx4 v111, s[28:31], s52 offen lds
    v_cvt_pk_bf16_f32 v49, v18, v19
    v_exp_f32 v21, v21
    v_exp_f32 v22, v22
    v_cvt_pk_bf16_f32 v50, v20, v21
    v_exp_f32 v23, v23
    v_mfma_f32_32x32x16_bf16 v[32:47], v[76:79], v[12:15], v[32:47]
    ds_read_b128 v[76:79], v1 offset:58368
    s_add_u32 m0, s49, 1024
    s_add_u32 s52, s68, 14592
    v_exp_f32 v24, v24
    buffer_load_dwordx4 v111, s[28:31], s52 offen lds
    v_cvt_pk_bf16_f32 v51, v22, v23
    v_exp_f32 v25, v25
    v_exp_f32 v26, v26
    v_cvt_pk_bf16_f32 v52, v24, v25
    v_exp_f32 v27, v27
    v_mfma_f32_32x32x16_bf16 v[56:71], v[80:83], v[48:51], v[56:71]
    ds_read_b128 v[80:83], v1 offset:55296
    v_exp_f32 v28, v28
    v_cvt_pk_bf16_f32 v53, v26, v27
    v_exp_f32 v29, v29
    v_exp_f32 v30, v30
    v_exp_f32 v31, v31
    v_cvt_pk_bf16_f32 v54, v28, v29
    v_cvt_pk_bf16_f32 v55, v30, v31
    s_waitcnt lgkmcnt(2)
    v_mfma_f32_32x32x16_bf16 v[16:31], v[72:75], v[8:11], v[88:103]
    ds_read_b128 v[72:75], v1 offset:61440
    v_exp_f32 v32, v32
    v_exp_f32 v33, v33
    v_exp_f32 v34, v34
    v_cvt_pk_bf16_f32 v48, v32, v33
    v_exp_f32 v35, v35
    v_mfma_f32_32x32x16_bf16 v[56:71], v[84:87], v[52:55], v[56:71]
    ds_read_b128 v[84:87], v1 offset:56320
    s_add_u32 m0, s49, 2048
    s_add_u32 s52, s68, 28928
    v_exp_f32 v36, v36
    buffer_load_dwordx4 v111, s[28:31], s52 offen lds
    v_cvt_pk_bf16_f32 v49, v34, v35
    v_exp_f32 v37, v37
    v_exp_f32 v38, v38
    v_cvt_pk_bf16_f32 v50, v36, v37
    v_exp_f32 v39, v39
    s_waitcnt lgkmcnt(2)
    v_mfma_f32_32x32x16_bf16 v[16:31], v[76:79], v[12:15], v[16:31]
    ds_read_b128 v[76:79], v1 offset:62464
    s_add_u32 m0, s49, 3072
    s_add_u32 s52, s68, 43264
    v_exp_f32 v40, v40
    buffer_load_dwordx4 v111, s[28:31], s52 offen lds
    v_cvt_pk_bf16_f32 v51, v38, v39
    v_exp_f32 v41, v41
    v_exp_f32 v42, v42
    v_cvt_pk_bf16_f32 v52, v40, v41
    v_exp_f32 v43, v43
    v_mfma_f32_32x32x16_bf16 v[56:71], v[80:83], v[48:51], v[56:71]
    ds_read_b128 v[80:83], v1 offset:59392
    v_exp_f32 v44, v44
    v_cvt_pk_bf16_f32 v53, v42, v43
    v_exp_f32 v45, v45
    v_exp_f32 v46, v46
    v_exp_f32 v47, v47
    v_cvt_pk_bf16_f32 v54, v44, v45
    v_cvt_pk_bf16_f32 v55, v46, v47
    s_setprio 0
    s_waitcnt lgkmcnt(2)
    v_mfma_f32_32x32x16_bf16 v[32:47], v[72:75], v[8:11], v[88:103]
    ds_read_b128 v[72:75], v2
    v_exp_f32 v16, v16
    v_exp_f32 v17, v17
    v_exp_f32 v18, v18
    v_cvt_pk_bf16_f32 v48, v16, v17
    v_exp_f32 v19, v19
    v_mfma_f32_32x32x16_bf16 v[56:71], v[84:87], v[52:55], v[56:71]
    ds_read_b128 v[84:87], v1 offset:60416
    s_add_u32 m0, s49, 4096
    s_add_u32 s52, s68, 57600
    v_exp_f32 v20, v20
    buffer_load_dwordx4 v111, s[28:31], s52 offen lds
    v_cvt_pk_bf16_f32 v49, v18, v19
    v_exp_f32 v21, v21
    v_exp_f32 v22, v22
    v_cvt_pk_bf16_f32 v50, v20, v21
    v_exp_f32 v23, v23
    s_waitcnt lgkmcnt(2)
    v_mfma_f32_32x32x16_bf16 v[32:47], v[76:79], v[12:15], v[32:47]
    ds_read_b128 v[76:79], v2 offset:1024
    s_add_u32 m0, s49, 5120
    s_add_u32 s52, s68, 71936
    v_exp_f32 v24, v24
    buffer_load_dwordx4 v111, s[28:31], s52 offen lds
    v_cvt_pk_bf16_f32 v51, v22, v23
    v_exp_f32 v25, v25
    v_exp_f32 v26, v26
    v_cvt_pk_bf16_f32 v52, v24, v25
    v_exp_f32 v27, v27
    v_mfma_f32_32x32x16_bf16 v[56:71], v[80:83], v[48:51], v[56:71]
    ds_read_b128 v[80:83], v1 offset:63488
    v_exp_f32 v28, v28
    v_cvt_pk_bf16_f32 v53, v26, v27
    v_exp_f32 v29, v29
    v_exp_f32 v30, v30
    v_exp_f32 v31, v31
    v_cvt_pk_bf16_f32 v54, v28, v29
    v_cvt_pk_bf16_f32 v55, v30, v31
    s_waitcnt lgkmcnt(2)
    v_mfma_f32_32x32x16_bf16 v[16:31], v[72:75], v[8:11], v[88:103]
    ds_read_b128 v[72:75], v2 offset:4096
    v_exp_f32 v32, v32
    v_exp_f32 v33, v33
    v_exp_f32 v34, v34
    v_cvt_pk_bf16_f32 v48, v32, v33
    v_exp_f32 v35, v35
    v_mfma_f32_32x32x16_bf16 v[56:71], v[84:87], v[52:55], v[56:71]
    ds_read_b128 v[84:87], v1 offset:64512
    s_add_u32 m0, s49, 6144
    s_add_u32 s52, s68, 86272
    v_exp_f32 v36, v36
    buffer_load_dwordx4 v111, s[28:31], s52 offen lds
    v_cvt_pk_bf16_f32 v49, v34, v35
    v_exp_f32 v37, v37
    v_exp_f32 v38, v38
    v_cvt_pk_bf16_f32 v50, v36, v37
    v_exp_f32 v39, v39
    s_waitcnt lgkmcnt(2)
    v_mfma_f32_32x32x16_bf16 v[16:31], v[76:79], v[12:15], v[16:31]
    ds_read_b128 v[76:79], v2 offset:5120
    v_exp_f32 v40, v40
    v_cvt_pk_bf16_f32 v51, v38, v39
    v_exp_f32 v41, v41
    v_exp_f32 v42, v42
    v_cvt_pk_bf16_f32 v52, v40, v41
    v_exp_f32 v43, v43
    v_mfma_f32_32x32x16_bf16 v[56:71], v[80:83], v[48:51], v[56:71]
    ds_read_b128 v[80:83], v2 offset:2048
    v_exp_f32 v44, v44
    v_cvt_pk_bf16_f32 v53, v42, v43
    v_exp_f32 v45, v45
    v_exp_f32 v46, v46
    v_exp_f32 v47, v47
    v_cvt_pk_bf16_f32 v54, v44, v45
    v_cvt_pk_bf16_f32 v55, v46, v47
    s_waitcnt vmcnt(7) lgkmcnt(2)
    s_barrier
    s_setprio 3
    s_add_u32 m0, s48, 32768
    s_xor_b32 s51, s81, 229376
    v_mfma_f32_32x32x16_bf16 v[32:47], v[72:75], v[8:11], v[88:103]
    ds_read_b128 v[72:75], v2 offset:8192
    v_exp_f32 v16, v16
    v_exp_f32 v17, v17
    v_exp_f32 v18, v18
    v_cvt_pk_bf16_f32 v48, v16, v17
    v_exp_f32 v19, v19
    v_mfma_f32_32x32x16_bf16 v[56:71], v[84:87], v[52:55], v[56:71]
    ds_read_b128 v[84:87], v2 offset:3072
    buffer_load_dwordx4 v1, s[24:27], s51 offen sc1 lds
    v_exp_f32 v20, v20
    v_cvt_pk_bf16_f32 v49, v18, v19
    v_exp_f32 v21, v21
    v_exp_f32 v22, v22
    v_cvt_pk_bf16_f32 v50, v20, v21
    v_exp_f32 v23, v23
    s_waitcnt lgkmcnt(2)
    v_mfma_f32_32x32x16_bf16 v[32:47], v[76:79], v[12:15], v[32:47]
    ds_read_b128 v[76:79], v2 offset:9216
    v_exp_f32 v24, v24
    v_cvt_pk_bf16_f32 v51, v22, v23
    v_exp_f32 v25, v25
    v_exp_f32 v26, v26
    v_cvt_pk_bf16_f32 v52, v24, v25
    v_exp_f32 v27, v27
    v_mfma_f32_32x32x16_bf16 v[56:71], v[80:83], v[48:51], v[56:71]
    ds_read_b128 v[80:83], v2 offset:6144
    v_exp_f32 v28, v28
    v_cvt_pk_bf16_f32 v53, v26, v27
    v_exp_f32 v29, v29
    v_exp_f32 v30, v30
    v_exp_f32 v31, v31
    v_cvt_pk_bf16_f32 v54, v28, v29
    v_cvt_pk_bf16_f32 v55, v30, v31
    s_waitcnt lgkmcnt(2)
    v_mfma_f32_32x32x16_bf16 v[16:31], v[72:75], v[8:11], v[88:103]
    ds_read_b128 v[72:75], v2 offset:12288
    v_exp_f32 v32, v32
    v_exp_f32 v33, v33
    v_exp_f32 v34, v34
    v_cvt_pk_bf16_f32 v48, v32, v33
    v_exp_f32 v35, v35
    v_mfma_f32_32x32x16_bf16 v[56:71], v[84:87], v[52:55], v[56:71]
    ds_read_b128 v[84:87], v2 offset:7168
    buffer_load_dwordx4 v1, s[24:27], s51 offen offset:1024 sc1 lds
    v_exp_f32 v36, v36
    v_cvt_pk_bf16_f32 v49, v34, v35
    v_exp_f32 v37, v37
    v_exp_f32 v38, v38
    v_cvt_pk_bf16_f32 v50, v36, v37
    v_exp_f32 v39, v39
    s_waitcnt lgkmcnt(2)
    v_mfma_f32_32x32x16_bf16 v[16:31], v[76:79], v[12:15], v[16:31]
    ds_read_b128 v[76:79], v2 offset:13312
    v_exp_f32 v40, v40
    v_cvt_pk_bf16_f32 v51, v38, v39
    v_exp_f32 v41, v41
    v_exp_f32 v42, v42
    v_cvt_pk_bf16_f32 v52, v40, v41
    v_exp_f32 v43, v43
    v_mfma_f32_32x32x16_bf16 v[56:71], v[80:83], v[48:51], v[56:71]
    ds_read_b128 v[80:83], v2 offset:10240
    v_exp_f32 v44, v44
    v_cvt_pk_bf16_f32 v53, v42, v43
    v_exp_f32 v45, v45
    v_exp_f32 v46, v46
    v_exp_f32 v47, v47
    v_cvt_pk_bf16_f32 v54, v44, v45
    v_cvt_pk_bf16_f32 v55, v46, v47
    s_setprio 2
    s_waitcnt lgkmcnt(2)
    v_mfma_f32_32x32x16_bf16 v[32:47], v[72:75], v[8:11], v[88:103]
    ds_read_b128 v[72:75], v2 offset:16384
    v_exp_f32 v16, v16
    v_exp_f32 v17, v17
    v_exp_f32 v18, v18
    v_cvt_pk_bf16_f32 v48, v16, v17
    v_exp_f32 v19, v19
    v_mfma_f32_32x32x16_bf16 v[56:71], v[84:87], v[52:55], v[56:71]
    ds_read_b128 v[84:87], v2 offset:11264
    buffer_load_dwordx4 v1, s[24:27], s51 offen offset:2048 sc1 lds
    v_exp_f32 v20, v20
    v_cvt_pk_bf16_f32 v49, v18, v19
    v_exp_f32 v21, v21
    v_exp_f32 v22, v22
    v_cvt_pk_bf16_f32 v50, v20, v21
    v_exp_f32 v23, v23
    s_waitcnt lgkmcnt(2)
    v_mfma_f32_32x32x16_bf16 v[32:47], v[76:79], v[12:15], v[32:47]
    ds_read_b128 v[76:79], v2 offset:17408
    v_exp_f32 v24, v24
    v_cvt_pk_bf16_f32 v51, v22, v23
    v_exp_f32 v25, v25
    v_exp_f32 v26, v26
    v_cvt_pk_bf16_f32 v52, v24, v25
    v_exp_f32 v27, v27
    v_mfma_f32_32x32x16_bf16 v[56:71], v[80:83], v[48:51], v[56:71]
    ds_read_b128 v[80:83], v2 offset:14336
    v_exp_f32 v28, v28
    v_cvt_pk_bf16_f32 v53, v26, v27
    v_exp_f32 v29, v29
    v_exp_f32 v30, v30
    v_exp_f32 v31, v31
    v_cvt_pk_bf16_f32 v54, v28, v29
    v_cvt_pk_bf16_f32 v55, v30, v31
    s_waitcnt lgkmcnt(2)
    v_mfma_f32_32x32x16_bf16 v[16:31], v[72:75], v[8:11], v[88:103]
    ds_read_b128 v[72:75], v2 offset:20480
    v_exp_f32 v32, v32
    v_exp_f32 v33, v33
    v_exp_f32 v34, v34
    v_cvt_pk_bf16_f32 v48, v32, v33
    v_exp_f32 v35, v35
    v_mfma_f32_32x32x16_bf16 v[56:71], v[84:87], v[52:55], v[56:71]
    ds_read_b128 v[84:87], v2 offset:15360
    buffer_load_dwordx4 v1, s[24:27], s51 offen offset:3072 sc1 lds
    v_exp_f32 v36, v36
    v_cvt_pk_bf16_f32 v49, v34, v35
    v_exp_f32 v37, v37
    v_exp_f32 v38, v38
    v_cvt_pk_bf16_f32 v50, v36, v37
    v_exp_f32 v39, v39
    s_waitcnt lgkmcnt(2)
    v_mfma_f32_32x32x16_bf16 v[16:31], v[76:79], v[12:15], v[16:31]
    ds_read_b128 v[76:79], v2 offset:21504
    v_exp_f32 v40, v40
    v_cvt_pk_bf16_f32 v51, v38, v39
    v_exp_f32 v41, v41
    v_exp_f32 v42, v42
    v_cvt_pk_bf16_f32 v52, v40, v41
    v_exp_f32 v43, v43
    v_mfma_f32_32x32x16_bf16 v[56:71], v[80:83], v[48:51], v[56:71]
    ds_read_b128 v[80:83], v2 offset:18432
    v_exp_f32 v44, v44
    v_cvt_pk_bf16_f32 v53, v42, v43
    v_exp_f32 v45, v45
    v_exp_f32 v46, v46
    v_exp_f32 v47, v47
    v_cvt_pk_bf16_f32 v54, v44, v45
    v_cvt_pk_bf16_f32 v55, v46, v47
    s_setprio 1
    s_waitcnt lgkmcnt(2)
    v_mfma_f32_32x32x16_bf16 v[32:47], v[72:75], v[8:11], v[88:103]
    ds_read_b128 v[72:75], v2 offset:24576
    v_exp_f32 v16, v16
    v_exp_f32 v17, v17
    v_exp_f32 v18, v18
    v_cvt_pk_bf16_f32 v48, v16, v17
    v_exp_f32 v19, v19
    v_mfma_f32_32x32x16_bf16 v[56:71], v[84:87], v[52:55], v[56:71]
    ds_read_b128 v[84:87], v2 offset:19456
    v_exp_f32 v20, v20
    v_cvt_pk_bf16_f32 v49, v18, v19
    v_exp_f32 v21, v21
    v_exp_f32 v22, v22
    v_cvt_pk_bf16_f32 v50, v20, v21
    v_exp_f32 v23, v23
    s_waitcnt lgkmcnt(2)
    v_mfma_f32_32x32x16_bf16 v[32:47], v[76:79], v[12:15], v[32:47]
    ds_read_b128 v[76:79], v2 offset:25600
    v_exp_f32 v24, v24
    v_cvt_pk_bf16_f32 v51, v22, v23
    v_exp_f32 v25, v25
    v_exp_f32 v26, v26
    v_cvt_pk_bf16_f32 v52, v24, v25
    v_exp_f32 v27, v27
    v_mfma_f32_32x32x16_bf16 v[56:71], v[80:83], v[48:51], v[56:71]
    ds_read_b128 v[80:83], v2 offset:22528
    v_exp_f32 v28, v28
    v_cvt_pk_bf16_f32 v53, v26, v27
    v_exp_f32 v29, v29
    v_exp_f32 v30, v30
    v_exp_f32 v31, v31
    v_cvt_pk_bf16_f32 v54, v28, v29
    v_cvt_pk_bf16_f32 v55, v30, v31
    s_waitcnt lgkmcnt(2)
    v_mfma_f32_32x32x16_bf16 v[16:31], v[72:75], v[8:11], v[88:103]
    ds_read_b128 v[72:75], v2 offset:28672
    v_exp_f32 v32, v32
    v_exp_f32 v33, v33
    v_exp_f32 v34, v34
    v_cvt_pk_bf16_f32 v48, v32, v33
    v_exp_f32 v35, v35
    v_mfma_f32_32x32x16_bf16 v[56:71], v[84:87], v[52:55], v[56:71]
    ds_read_b128 v[84:87], v2 offset:23552
    v_exp_f32 v36, v36
    v_cvt_pk_bf16_f32 v49, v34, v35
    v_exp_f32 v37, v37
    v_exp_f32 v38, v38
    v_cvt_pk_bf16_f32 v50, v36, v37
    v_exp_f32 v39, v39
    s_waitcnt lgkmcnt(2)
    v_mfma_f32_32x32x16_bf16 v[16:31], v[76:79], v[12:15], v[16:31]
    ds_read_b128 v[76:79], v2 offset:29696
    v_exp_f32 v40, v40
    v_cvt_pk_bf16_f32 v51, v38, v39
    v_exp_f32 v41, v41
    v_exp_f32 v42, v42
    v_cvt_pk_bf16_f32 v52, v40, v41
    v_exp_f32 v43, v43
    v_mfma_f32_32x32x16_bf16 v[56:71], v[80:83], v[48:51], v[56:71]
    ds_read_b128 v[80:83], v2 offset:26624
    v_exp_f32 v44, v44
    v_cvt_pk_bf16_f32 v53, v42, v43
    v_exp_f32 v45, v45
    v_exp_f32 v46, v46
    v_exp_f32 v47, v47
    v_cvt_pk_bf16_f32 v54, v44, v45
    v_cvt_pk_bf16_f32 v55, v46, v47
    s_setprio 0
    s_waitcnt lgkmcnt(2)
    v_mfma_f32_32x32x16_bf16 v[32:47], v[72:75], v[8:11], v[88:103]
    ds_read_b128 v[72:75], v1
    v_exp_f32 v16, v16
    v_exp_f32 v17, v17
    v_exp_f32 v18, v18
    v_cvt_pk_bf16_f32 v48, v16, v17
    v_exp_f32 v19, v19
    v_mfma_f32_32x32x16_bf16 v[56:71], v[84:87], v[52:55], v[56:71]
    ds_read_b128 v[84:87], v2 offset:27648
    v_exp_f32 v20, v20
    v_cvt_pk_bf16_f32 v49, v18, v19
    v_exp_f32 v21, v21
    v_exp_f32 v22, v22
    v_cvt_pk_bf16_f32 v50, v20, v21
    v_exp_f32 v23, v23
    s_waitcnt lgkmcnt(2)
    v_mfma_f32_32x32x16_bf16 v[32:47], v[76:79], v[12:15], v[32:47]
    ds_read_b128 v[76:79], v1 offset:1024
    v_exp_f32 v24, v24
    v_cvt_pk_bf16_f32 v51, v22, v23
    v_exp_f32 v25, v25
    v_exp_f32 v26, v26
    v_cvt_pk_bf16_f32 v52, v24, v25
    v_exp_f32 v27, v27
    v_mfma_f32_32x32x16_bf16 v[56:71], v[80:83], v[48:51], v[56:71]
    ds_read_b128 v[80:83], v2 offset:30720
    v_exp_f32 v28, v28
    v_cvt_pk_bf16_f32 v53, v26, v27
    v_exp_f32 v29, v29
    v_exp_f32 v30, v30
    v_exp_f32 v31, v31
    v_cvt_pk_bf16_f32 v54, v28, v29
    v_cvt_pk_bf16_f32 v55, v30, v31
    s_waitcnt lgkmcnt(2)
    v_mfma_f32_32x32x16_bf16 v[16:31], v[72:75], v[8:11], v[88:103]
    ds_read_b128 v[72:75], v1 offset:4096
    v_exp_f32 v32, v32
    v_exp_f32 v33, v33
    v_exp_f32 v34, v34
    v_cvt_pk_bf16_f32 v48, v32, v33
    v_exp_f32 v35, v35
    v_mfma_f32_32x32x16_bf16 v[56:71], v[84:87], v[52:55], v[56:71]
    ds_read_b128 v[84:87], v2 offset:31744
    v_exp_f32 v36, v36
    v_cvt_pk_bf16_f32 v49, v34, v35
    v_exp_f32 v37, v37
    v_exp_f32 v38, v38
    v_cvt_pk_bf16_f32 v50, v36, v37
    v_exp_f32 v39, v39
    s_waitcnt lgkmcnt(2)
    v_mfma_f32_32x32x16_bf16 v[16:31], v[76:79], v[12:15], v[16:31]
    ds_read_b128 v[76:79], v1 offset:5120
    v_exp_f32 v40, v40
    v_cvt_pk_bf16_f32 v51, v38, v39
    v_exp_f32 v41, v41
    v_exp_f32 v42, v42
    v_cvt_pk_bf16_f32 v52, v40, v41
    v_exp_f32 v43, v43
    v_mfma_f32_32x32x16_bf16 v[56:71], v[80:83], v[48:51], v[56:71]
    ds_read_b128 v[80:83], v1 offset:2048
    v_exp_f32 v44, v44
    v_cvt_pk_bf16_f32 v53, v42, v43
    v_exp_f32 v45, v45
    v_exp_f32 v46, v46
    v_exp_f32 v47, v47
    v_cvt_pk_bf16_f32 v54, v44, v45
    v_cvt_pk_bf16_f32 v55, v46, v47
    s_waitcnt vmcnt(0) lgkmcnt(2)
    s_barrier
    s_setprio 3
    v_mfma_f32_32x32x16_bf16 v[32:47], v[72:75], v[8:11], v[88:103]
    ds_read_b128 v[72:75], v1 offset:8192
    v_exp_f32 v16, v16
    v_exp_f32 v17, v17
    v_exp_f32 v18, v18
    v_cvt_pk_bf16_f32 v48, v16, v17
    v_exp_f32 v19, v19
    v_mfma_f32_32x32x16_bf16 v[56:71], v[84:87], v[52:55], v[56:71]
    ds_read_b128 v[84:87], v1 offset:3072
    v_exp_f32 v20, v20
    v_cvt_pk_bf16_f32 v49, v18, v19
    v_exp_f32 v21, v21
    v_exp_f32 v22, v22
    v_cvt_pk_bf16_f32 v50, v20, v21
    v_exp_f32 v23, v23
    s_waitcnt lgkmcnt(2)
    v_mfma_f32_32x32x16_bf16 v[32:47], v[76:79], v[12:15], v[32:47]
    ds_read_b128 v[76:79], v1 offset:9216
    v_exp_f32 v24, v24
    v_cvt_pk_bf16_f32 v51, v22, v23
    v_exp_f32 v25, v25
    v_exp_f32 v26, v26
    v_cvt_pk_bf16_f32 v52, v24, v25
    v_exp_f32 v27, v27
    v_mfma_f32_32x32x16_bf16 v[56:71], v[80:83], v[48:51], v[56:71]
    ds_read_b128 v[80:83], v1 offset:6144
    ds_read_b64_tr_b16 v[192:193], v6
    ds_read_b64_tr_b16 v[194:195], v6 offset:512
    ds_read_b64_tr_b16 v[196:197], v6 offset:1024
    ds_read_b64_tr_b16 v[198:199], v7 offset:1536
    v_exp_f32 v28, v28
    v_cvt_pk_bf16_f32 v53, v26, v27
    v_exp_f32 v29, v29
    v_exp_f32 v30, v30
    v_exp_f32 v31, v31
    v_cvt_pk_bf16_f32 v54, v28, v29
    v_cvt_pk_bf16_f32 v55, v30, v31
    s_waitcnt lgkmcnt(6)
    v_mfma_f32_32x32x16_bf16 v[16:31], v[72:75], v[8:11], v[88:103]
    ds_read_b128 v[72:75], v1 offset:12288
    v_exp_f32 v32, v32
    v_exp_f32 v33, v33
    v_exp_f32 v34, v34
    v_cvt_pk_bf16_f32 v48, v32, v33
    v_exp_f32 v35, v35
    v_mfma_f32_32x32x16_bf16 v[56:71], v[84:87], v[52:55], v[56:71]
    ds_read_b128 v[84:87], v1 offset:7168
    v_exp_f32 v36, v36
    v_cvt_pk_bf16_f32 v49, v34, v35
    v_exp_f32 v37, v37
    v_exp_f32 v38, v38
    v_cvt_pk_bf16_f32 v50, v36, v37
    v_exp_f32 v39, v39
    s_waitcnt lgkmcnt(6)
    v_mfma_f32_32x32x16_bf16 v[16:31], v[76:79], v[12:15], v[16:31]
    ds_read_b128 v[76:79], v1 offset:13312
    v_exp_f32 v40, v40
    v_cvt_pk_bf16_f32 v51, v38, v39
    v_exp_f32 v41, v41
    v_exp_f32 v42, v42
    v_cvt_pk_bf16_f32 v52, v40, v41
    v_exp_f32 v43, v43
    v_mfma_f32_32x32x16_bf16 v[56:71], v[80:83], v[48:51], v[56:71]
    ds_read_b128 v[80:83], v1 offset:10240
    ds_read_b64_tr_b16 v[200:201], v6 offset:1792
    ds_read_b64_tr_b16 v[202:203], v6 offset:2304
    ds_read_b64_tr_b16 v[204:205], v6 offset:2816
    ds_read_b64_tr_b16 v[206:207], v7 offset:3328
    v_exp_f32 v44, v44
    v_cvt_pk_bf16_f32 v53, v42, v43
    v_exp_f32 v45, v45
    v_exp_f32 v46, v46
    v_exp_f32 v47, v47
    v_cvt_pk_bf16_f32 v54, v44, v45
    v_cvt_pk_bf16_f32 v55, v46, v47
    s_setprio 2
    s_waitcnt lgkmcnt(6)
    v_mfma_f32_32x32x16_bf16 v[32:47], v[72:75], v[8:11], v[88:103]
    ds_read_b128 v[72:75], v1 offset:16384
    v_exp_f32 v16, v16
    v_exp_f32 v17, v17
    v_exp_f32 v18, v18
    v_cvt_pk_bf16_f32 v48, v16, v17
    v_exp_f32 v19, v19
    v_mfma_f32_32x32x16_bf16 v[56:71], v[84:87], v[52:55], v[56:71]
    ds_read_b128 v[84:87], v1 offset:11264
    v_exp_f32 v20, v20
    v_cvt_pk_bf16_f32 v49, v18, v19
    v_exp_f32 v21, v21
    v_exp_f32 v22, v22
    v_cvt_pk_bf16_f32 v50, v20, v21
    v_exp_f32 v23, v23
    s_waitcnt lgkmcnt(6)
    v_mfma_f32_32x32x16_bf16 v[32:47], v[76:79], v[12:15], v[32:47]
    ds_read_b128 v[76:79], v1 offset:17408
    v_exp_f32 v24, v24
    v_cvt_pk_bf16_f32 v51, v22, v23
    v_exp_f32 v25, v25
    v_exp_f32 v26, v26
    v_cvt_pk_bf16_f32 v52, v24, v25
    v_exp_f32 v27, v27
    v_mfma_f32_32x32x16_bf16 v[56:71], v[80:83], v[48:51], v[56:71]
    ds_read_b128 v[80:83], v1 offset:14336
    ds_read_b64_tr_b16 v[208:209], v6 offset:3584
    ds_read_b64_tr_b16 v[210:211], v6 offset:4096
    ds_read_b64_tr_b16 v[212:213], v6 offset:4608
    ds_read_b64_tr_b16 v[214:215], v7 offset:5120
    v_exp_f32 v28, v28
    v_cvt_pk_bf16_f32 v53, v26, v27
    v_exp_f32 v29, v29
    v_exp_f32 v30, v30
    v_exp_f32 v31, v31
    v_cvt_pk_bf16_f32 v54, v28, v29
    v_cvt_pk_bf16_f32 v55, v30, v31
    s_waitcnt lgkmcnt(6)
    v_mfma_f32_32x32x16_bf16 v[16:31], v[72:75], v[8:11], v[88:103]
    ds_read_b128 v[72:75], v1 offset:20480
    v_exp_f32 v32, v32
    v_exp_f32 v33, v33
    v_exp_f32 v34, v34
    v_cvt_pk_bf16_f32 v48, v32, v33
    v_exp_f32 v35, v35
    v_mfma_f32_32x32x16_bf16 v[56:71], v[84:87], v[52:55], v[56:71]
    ds_read_b128 v[84:87], v1 offset:15360
    v_exp_f32 v36, v36
    v_cvt_pk_bf16_f32 v49, v34, v35
    v_exp_f32 v37, v37
    v_exp_f32 v38, v38
    v_cvt_pk_bf16_f32 v50, v36, v37
    v_exp_f32 v39, v39
    s_waitcnt lgkmcnt(6)
    v_mfma_f32_32x32x16_bf16 v[16:31], v[76:79], v[12:15], v[16:31]
    ds_read_b128 v[76:79], v1 offset:21504
    v_exp_f32 v40, v40
    v_cvt_pk_bf16_f32 v51, v38, v39
    v_exp_f32 v41, v41
    v_exp_f32 v42, v42
    v_cvt_pk_bf16_f32 v52, v40, v41
    v_exp_f32 v43, v43
    v_mfma_f32_32x32x16_bf16 v[56:71], v[80:83], v[48:51], v[56:71]
    ds_read_b128 v[80:83], v1 offset:18432
    ds_read_b64_tr_b16 v[216:217], v6 offset:5376
    ds_read_b64_tr_b16 v[218:219], v6 offset:5888
    ds_read_b64_tr_b16 v[220:221], v6 offset:6400
    ds_read_b64_tr_b16 v[222:223], v7 offset:6912
    v_exp_f32 v44, v44
    v_cvt_pk_bf16_f32 v53, v42, v43
    v_exp_f32 v45, v45
    v_exp_f32 v46, v46
    v_exp_f32 v47, v47
    v_cvt_pk_bf16_f32 v54, v44, v45
    v_cvt_pk_bf16_f32 v55, v46, v47
    s_setprio 1
    s_waitcnt lgkmcnt(6)
    v_mfma_f32_32x32x16_bf16 v[32:47], v[72:75], v[8:11], v[88:103]
    ds_read_b128 v[72:75], v1 offset:24576
    v_exp_f32 v16, v16
    v_exp_f32 v17, v17
    v_exp_f32 v18, v18
    v_cvt_pk_bf16_f32 v48, v16, v17
    v_exp_f32 v19, v19
    v_mfma_f32_32x32x16_bf16 v[56:71], v[84:87], v[52:55], v[56:71]
    ds_read_b128 v[84:87], v1 offset:19456
    s_waitcnt lgkmcnt(2)
    s_add_u32 m0, s49, 0
    s_add_u32 s52, s69, 256
    v_exp_f32 v20, v20
    buffer_load_dwordx4 v111, s[28:31], s52 offen lds
    v_cvt_pk_bf16_f32 v49, v18, v19
    v_exp_f32 v21, v21
    v_exp_f32 v22, v22
    v_cvt_pk_bf16_f32 v50, v20, v21
    v_exp_f32 v23, v23
    v_mfma_f32_32x32x16_bf16 v[32:47], v[76:79], v[12:15], v[32:47]
    ds_read_b128 v[76:79], v1 offset:25600
    s_add_u32 m0, s49, 1024
    s_add_u32 s52, s69, 14592
    v_exp_f32 v24, v24
    buffer_load_dwordx4 v111, s[28:31], s52 offen lds
    v_cvt_pk_bf16_f32 v51, v22, v23
    v_exp_f32 v25, v25
    v_exp_f32 v26, v26
    v_cvt_pk_bf16_f32 v52, v24, v25
    v_exp_f32 v27, v27
    v_mfma_f32_32x32x16_bf16 v[56:71], v[80:83], v[48:51], v[56:71]
    ds_read_b128 v[80:83], v1 offset:22528
    v_exp_f32 v28, v28
    v_cvt_pk_bf16_f32 v53, v26, v27
    v_exp_f32 v29, v29
    v_exp_f32 v30, v30
    v_exp_f32 v31, v31
    v_cvt_pk_bf16_f32 v54, v28, v29
    v_cvt_pk_bf16_f32 v55, v30, v31
    s_waitcnt lgkmcnt(2)
    v_mfma_f32_32x32x16_bf16 v[16:31], v[72:75], v[8:11], v[88:103]
    ds_read_b128 v[72:75], v1 offset:28672
    v_exp_f32 v32, v32
    v_exp_f32 v33, v33
    v_exp_f32 v34, v34
    v_cvt_pk_bf16_f32 v48, v32, v33
    v_exp_f32 v35, v35
    v_mfma_f32_32x32x16_bf16 v[56:71], v[84:87], v[52:55], v[56:71]
    ds_read_b128 v[84:87], v1 offset:23552
    s_add_u32 m0, s49, 2048
    s_add_u32 s52, s69, 28928
    v_exp_f32 v36, v36
    buffer_load_dwordx4 v111, s[28:31], s52 offen lds
    v_cvt_pk_bf16_f32 v49, v34, v35
    v_exp_f32 v37, v37
    v_exp_f32 v38, v38
    v_cvt_pk_bf16_f32 v50, v36, v37
    v_exp_f32 v39, v39
    s_waitcnt lgkmcnt(2)
    v_mfma_f32_32x32x16_bf16 v[16:31], v[76:79], v[12:15], v[16:31]
    ds_read_b128 v[76:79], v1 offset:29696
    s_add_u32 m0, s49, 3072
    s_add_u32 s52, s69, 43264
    v_exp_f32 v40, v40
    buffer_load_dwordx4 v111, s[28:31], s52 offen lds
    v_cvt_pk_bf16_f32 v51, v38, v39
    v_exp_f32 v41, v41
    v_exp_f32 v42, v42
    v_cvt_pk_bf16_f32 v52, v40, v41
    v_exp_f32 v43, v43
    v_mfma_f32_32x32x16_bf16 v[56:71], v[80:83], v[48:51], v[56:71]
    ds_read_b128 v[80:83], v1 offset:26624
    v_exp_f32 v44, v44
    v_cvt_pk_bf16_f32 v53, v42, v43
    v_exp_f32 v45, v45
    v_exp_f32 v46, v46
    v_exp_f32 v47, v47
    v_cvt_pk_bf16_f32 v54, v44, v45
    v_cvt_pk_bf16_f32 v55, v46, v47
    s_setprio 0
    s_waitcnt lgkmcnt(2)
    v_mfma_f32_32x32x16_bf16 v[32:47], v[72:75], v[8:11], v[88:103]
    ds_read_b128 v[72:75], v1 offset:32768
    v_exp_f32 v16, v16
    v_exp_f32 v17, v17
    v_exp_f32 v18, v18
    v_cvt_pk_bf16_f32 v48, v16, v17
    v_exp_f32 v19, v19
    v_mfma_f32_32x32x16_bf16 v[56:71], v[84:87], v[52:55], v[56:71]
    ds_read_b128 v[84:87], v1 offset:27648
    s_add_u32 m0, s49, 4096
    s_add_u32 s52, s69, 57600
    v_exp_f32 v20, v20
    buffer_load_dwordx4 v111, s[28:31], s52 offen lds
    v_cvt_pk_bf16_f32 v49, v18, v19
    v_exp_f32 v21, v21
    v_exp_f32 v22, v22
    v_cvt_pk_bf16_f32 v50, v20, v21
    v_exp_f32 v23, v23
    s_waitcnt lgkmcnt(2)
    v_mfma_f32_32x32x16_bf16 v[32:47], v[76:79], v[12:15], v[32:47]
    ds_read_b128 v[76:79], v1 offset:33792
    s_add_u32 m0, s49, 5120
    s_add_u32 s52, s69, 71936
    v_exp_f32 v24, v24
    buffer_load_dwordx4 v111, s[28:31], s52 offen lds
    v_cvt_pk_bf16_f32 v51, v22, v23
    v_exp_f32 v25, v25
    v_exp_f32 v26, v26
    v_cvt_pk_bf16_f32 v52, v24, v25
    v_exp_f32 v27, v27
    v_mfma_f32_32x32x16_bf16 v[56:71], v[80:83], v[48:51], v[56:71]
    ds_read_b128 v[80:83], v1 offset:30720
    v_exp_f32 v28, v28
    v_cvt_pk_bf16_f32 v53, v26, v27
    v_exp_f32 v29, v29
    v_exp_f32 v30, v30
    v_exp_f32 v31, v31
    v_cvt_pk_bf16_f32 v54, v28, v29
    v_cvt_pk_bf16_f32 v55, v30, v31
    s_waitcnt lgkmcnt(2)
    v_mfma_f32_32x32x16_bf16 v[16:31], v[72:75], v[8:11], v[88:103]
    ds_read_b128 v[72:75], v1 offset:36864
    v_exp_f32 v32, v32
    v_exp_f32 v33, v33
    v_exp_f32 v34, v34
    v_cvt_pk_bf16_f32 v48, v32, v33
    v_exp_f32 v35, v35
    v_mfma_f32_32x32x16_bf16 v[56:71], v[84:87], v[52:55], v[56:71]
    ds_read_b128 v[84:87], v1 offset:31744
    s_add_u32 m0, s49, 6144
    s_add_u32 s52, s69, 86272
    v_exp_f32 v36, v36
    buffer_load_dwordx4 v111, s[28:31], s52 offen lds
    v_cvt_pk_bf16_f32 v49, v34, v35
    v_exp_f32 v37, v37
    v_exp_f32 v38, v38
    v_cvt_pk_bf16_f32 v50, v36, v37
    v_exp_f32 v39, v39
    s_waitcnt lgkmcnt(2)
    v_mfma_f32_32x32x16_bf16 v[16:31], v[76:79], v[12:15], v[16:31]
    ds_read_b128 v[76:79], v1 offset:37888
    v_exp_f32 v40, v40
    v_cvt_pk_bf16_f32 v51, v38, v39
    v_exp_f32 v41, v41
    v_exp_f32 v42, v42
    v_cvt_pk_bf16_f32 v52, v40, v41
    v_exp_f32 v43, v43
    v_mfma_f32_32x32x16_bf16 v[56:71], v[80:83], v[48:51], v[56:71]
    ds_read_b128 v[80:83], v1 offset:34816
    v_exp_f32 v44, v44
    v_cvt_pk_bf16_f32 v53, v42, v43
    v_exp_f32 v45, v45
    v_exp_f32 v46, v46
    v_exp_f32 v47, v47
    v_cvt_pk_bf16_f32 v54, v44, v45
    v_cvt_pk_bf16_f32 v55, v46, v47
    s_setprio 3
    v_and_b32 v116, 3, v0
    v_lshlrev_b32 v116, 2, v116
    v_add_u32 v116, 159808, v116
    ds_read_b32 v119, v116
    v_and_b32 v3, 31, v0
    v_lshlrev_b32 v3, 2, v3
    s_lshl_b32 s3, s42, 8
    s_lshl_b32 s51, s44, 7
    s_add_u32 s3, s3, s51
    s_add_u32 s3, s3, 524288
    buffer_load_dword v125, v3, s[32:35], s3 offen sc1
    s_waitcnt lgkmcnt(3)
    v_mfma_f32_32x32x16_bf16 v[32:47], v[72:75], v[8:11], v[88:103]
    ds_read_b128 v[72:75], v1 offset:40960
    v_exp_f32 v16, v16
    v_exp_f32 v17, v17
    v_exp_f32 v18, v18
    v_cvt_pk_bf16_f32 v48, v16, v17
    v_exp_f32 v19, v19
    v_mfma_f32_32x32x16_bf16 v[56:71], v[84:87], v[52:55], v[56:71]
    ds_read_b128 v[84:87], v1 offset:35840
    v_exp_f32 v20, v20
    v_cvt_pk_bf16_f32 v49, v18, v19
    v_exp_f32 v21, v21
    v_exp_f32 v22, v22
    v_cvt_pk_bf16_f32 v50, v20, v21
    v_exp_f32 v23, v23
    s_waitcnt lgkmcnt(3)
    v_mfma_f32_32x32x16_bf16 v[32:47], v[76:79], v[12:15], v[32:47]
    ds_read_b128 v[76:79], v1 offset:41984
    v_exp_f32 v24, v24
    v_cvt_pk_bf16_f32 v51, v22, v23
    v_exp_f32 v25, v25
    v_exp_f32 v26, v26
    v_cvt_pk_bf16_f32 v52, v24, v25
    v_exp_f32 v27, v27
    v_mfma_f32_32x32x16_bf16 v[56:71], v[80:83], v[48:51], v[56:71]
    ds_read_b128 v[80:83], v1 offset:38912
    v_exp_f32 v28, v28
    v_cvt_pk_bf16_f32 v53, v26, v27
    v_exp_f32 v29, v29
    v_exp_f32 v30, v30
    v_exp_f32 v31, v31
    v_cvt_pk_bf16_f32 v54, v28, v29
    v_cvt_pk_bf16_f32 v55, v30, v31
    s_waitcnt lgkmcnt(2)
    v_mfma_f32_32x32x16_bf16 v[16:31], v[72:75], v[8:11], v[88:103]
    ds_read_b128 v[72:75], v1 offset:45056
    v_exp_f32 v32, v32
    v_exp_f32 v33, v33
    v_exp_f32 v34, v34
    v_cvt_pk_bf16_f32 v48, v32, v33
    v_exp_f32 v35, v35
    v_mfma_f32_32x32x16_bf16 v[56:71], v[84:87], v[52:55], v[56:71]
    ds_read_b128 v[84:87], v1 offset:39936
    v_exp_f32 v36, v36
    v_cvt_pk_bf16_f32 v49, v34, v35
    v_exp_f32 v37, v37
    v_exp_f32 v38, v38
    v_cvt_pk_bf16_f32 v50, v36, v37
    v_exp_f32 v39, v39
    s_waitcnt lgkmcnt(2)
    v_mfma_f32_32x32x16_bf16 v[16:31], v[76:79], v[12:15], v[16:31]
    ds_read_b128 v[76:79], v1 offset:46080
    v_exp_f32 v40, v40
    v_cvt_pk_bf16_f32 v51, v38, v39
    v_exp_f32 v41, v41
    v_exp_f32 v42, v42
    v_cvt_pk_bf16_f32 v52, v40, v41
    v_exp_f32 v43, v43
    v_mfma_f32_32x32x16_bf16 v[56:71], v[80:83], v[48:51], v[56:71]
    ds_read_b128 v[80:83], v1 offset:43008
    v_exp_f32 v44, v44
    v_cvt_pk_bf16_f32 v53, v42, v43
    v_exp_f32 v45, v45
    v_exp_f32 v46, v46
    v_exp_f32 v47, v47
    v_cvt_pk_bf16_f32 v54, v44, v45
    v_cvt_pk_bf16_f32 v55, v46, v47
    s_setprio 2
    s_waitcnt lgkmcnt(2)
    v_mfma_f32_32x32x16_bf16 v[32:47], v[72:75], v[8:11], v[88:103]
    ds_read_b128 v[72:75], v1 offset:49152
    v_exp_f32 v16, v16
    v_exp_f32 v17, v17
    v_exp_f32 v18, v18
    v_cvt_pk_bf16_f32 v48, v16, v17
    v_exp_f32 v19, v19
    v_mfma_f32_32x32x16_bf16 v[56:71], v[84:87], v[52:55], v[56:71]
    ds_read_b128 v[84:87], v1 offset:44032
    v_exp_f32 v20, v20
    v_cvt_pk_bf16_f32 v49, v18, v19
    v_exp_f32 v21, v21
    v_exp_f32 v22, v22
    v_cvt_pk_bf16_f32 v50, v20, v21
    v_exp_f32 v23, v23
    s_waitcnt lgkmcnt(2)
    v_mfma_f32_32x32x16_bf16 v[32:47], v[76:79], v[12:15], v[32:47]
    ds_read_b128 v[76:79], v1 offset:50176
    v_exp_f32 v24, v24
    v_cvt_pk_bf16_f32 v51, v22, v23
    v_exp_f32 v25, v25
    v_exp_f32 v26, v26
    v_cvt_pk_bf16_f32 v52, v24, v25
    v_exp_f32 v27, v27
    v_mfma_f32_32x32x16_bf16 v[56:71], v[80:83], v[48:51], v[56:71]
    ds_read_b128 v[80:83], v1 offset:47104
    v_exp_f32 v28, v28
    v_cvt_pk_bf16_f32 v53, v26, v27
    v_exp_f32 v29, v29
    v_exp_f32 v30, v30
    v_exp_f32 v31, v31
    v_cvt_pk_bf16_f32 v54, v28, v29
    v_cvt_pk_bf16_f32 v55, v30, v31
    s_waitcnt lgkmcnt(2)
    v_mfma_f32_32x32x16_bf16 v[16:31], v[72:75], v[8:11], v[88:103]
    ds_read_b128 v[72:75], v1 offset:53248
    v_exp_f32 v32, v32
    v_exp_f32 v33, v33
    v_exp_f32 v34, v34
    v_cvt_pk_bf16_f32 v48, v32, v33
    v_exp_f32 v35, v35
    v_mfma_f32_32x32x16_bf16 v[56:71], v[84:87], v[52:55], v[56:71]
    ds_read_b128 v[84:87], v1 offset:48128
    v_exp_f32 v36, v36
    v_cvt_pk_bf16_f32 v49, v34, v35
    v_exp_f32 v37, v37
    v_exp_f32 v38, v38
    v_cvt_pk_bf16_f32 v50, v36, v37
    v_exp_f32 v39, v39
    s_waitcnt lgkmcnt(2)
    v_mfma_f32_32x32x16_bf16 v[16:31], v[76:79], v[12:15], v[16:31]
    ds_read_b128 v[76:79], v1 offset:54272
    v_exp_f32 v40, v40
    v_cvt_pk_bf16_f32 v51, v38, v39
    v_exp_f32 v41, v41
    v_exp_f32 v42, v42
    v_cvt_pk_bf16_f32 v52, v40, v41
    v_exp_f32 v43, v43
    v_mfma_f32_32x32x16_bf16 v[56:71], v[80:83], v[48:51], v[56:71]
    ds_read_b128 v[80:83], v1 offset:51200
    v_exp_f32 v44, v44
    v_cvt_pk_bf16_f32 v53, v42, v43
    v_exp_f32 v45, v45
    v_exp_f32 v46, v46
    v_exp_f32 v47, v47
    v_cvt_pk_bf16_f32 v54, v44, v45
    v_cvt_pk_bf16_f32 v55, v46, v47
    s_setprio 1
    s_waitcnt lgkmcnt(2)
    v_mfma_f32_32x32x16_bf16 v[32:47], v[72:75], v[8:11], v[88:103]
    ds_read_b128 v[72:75], v1 offset:57344
    v_exp_f32 v16, v16
    v_exp_f32 v17, v17
    v_exp_f32 v18, v18
    v_cvt_pk_bf16_f32 v48, v16, v17
    v_exp_f32 v19, v19
    v_mfma_f32_32x32x16_bf16 v[56:71], v[84:87], v[52:55], v[56:71]
    ds_read_b128 v[84:87], v1 offset:52224
    v_exp_f32 v20, v20
    v_cvt_pk_bf16_f32 v49, v18, v19
    v_exp_f32 v21, v21
    v_exp_f32 v22, v22
    v_cvt_pk_bf16_f32 v50, v20, v21
    v_exp_f32 v23, v23
    s_waitcnt lgkmcnt(2)
    v_mfma_f32_32x32x16_bf16 v[32:47], v[76:79], v[12:15], v[32:47]
    ds_read_b128 v[76:79], v1 offset:58368
    v_exp_f32 v24, v24
    v_cvt_pk_bf16_f32 v51, v22, v23
    v_exp_f32 v25, v25
    v_exp_f32 v26, v26
    v_cvt_pk_bf16_f32 v52, v24, v25
    v_exp_f32 v27, v27
    v_mfma_f32_32x32x16_bf16 v[56:71], v[80:83], v[48:51], v[56:71]
    ds_read_b128 v[80:83], v1 offset:55296
    s_waitcnt vmcnt(1)
    ds_read_b64_tr_b16 v[224:225], v6
    ds_read_b64_tr_b16 v[226:227], v6 offset:512
    ds_read_b64_tr_b16 v[228:229], v6 offset:1024
    ds_read_b64_tr_b16 v[230:231], v7 offset:1536
    v_exp_f32 v28, v28
    v_cvt_pk_bf16_f32 v53, v26, v27
    v_exp_f32 v29, v29
    v_exp_f32 v30, v30
    v_exp_f32 v31, v31
    v_cvt_pk_bf16_f32 v54, v28, v29
    v_cvt_pk_bf16_f32 v55, v30, v31
    s_waitcnt lgkmcnt(6)
    v_mfma_f32_32x32x16_bf16 v[16:31], v[72:75], v[8:11], v[88:103]
    ds_read_b128 v[72:75], v1 offset:61440
    v_exp_f32 v32, v32
    v_exp_f32 v33, v33
    v_exp_f32 v34, v34
    v_cvt_pk_bf16_f32 v48, v32, v33
    v_exp_f32 v35, v35
    v_mfma_f32_32x32x16_bf16 v[56:71], v[84:87], v[52:55], v[56:71]
    ds_read_b128 v[84:87], v1 offset:56320
    v_exp_f32 v36, v36
    v_cvt_pk_bf16_f32 v49, v34, v35
    v_exp_f32 v37, v37
    v_exp_f32 v38, v38
    v_cvt_pk_bf16_f32 v50, v36, v37
    v_exp_f32 v39, v39
    s_waitcnt lgkmcnt(6)
    v_mfma_f32_32x32x16_bf16 v[16:31], v[76:79], v[12:15], v[16:31]
    ds_read_b128 v[76:79], v1 offset:62464
    v_exp_f32 v40, v40
    v_cvt_pk_bf16_f32 v51, v38, v39
    v_exp_f32 v41, v41
    v_exp_f32 v42, v42
    v_cvt_pk_bf16_f32 v52, v40, v41
    v_exp_f32 v43, v43
    v_mfma_f32_32x32x16_bf16 v[56:71], v[80:83], v[48:51], v[56:71]
    ds_read_b128 v[80:83], v1 offset:59392
    ds_read_b64_tr_b16 v[232:233], v6 offset:1792
    ds_read_b64_tr_b16 v[234:235], v6 offset:2304
    ds_read_b64_tr_b16 v[236:237], v6 offset:2816
    ds_read_b64_tr_b16 v[238:239], v7 offset:3328
    v_exp_f32 v44, v44
    v_cvt_pk_bf16_f32 v53, v42, v43
    v_exp_f32 v45, v45
    v_exp_f32 v46, v46
    v_exp_f32 v47, v47
    v_cvt_pk_bf16_f32 v54, v44, v45
    v_cvt_pk_bf16_f32 v55, v46, v47
    s_setprio 0
    s_waitcnt lgkmcnt(6)
    v_mfma_f32_32x32x16_bf16 v[32:47], v[72:75], v[8:11], v[88:103]
    v_exp_f32 v16, v16
    v_exp_f32 v17, v17
    v_exp_f32 v18, v18
    v_cvt_pk_bf16_f32 v48, v16, v17
    v_exp_f32 v19, v19
    v_mfma_f32_32x32x16_bf16 v[56:71], v[84:87], v[52:55], v[56:71]
    ds_read_b128 v[84:87], v1 offset:60416
    v_exp_f32 v20, v20
    v_cvt_pk_bf16_f32 v49, v18, v19
    v_exp_f32 v21, v21
    v_exp_f32 v22, v22
    v_cvt_pk_bf16_f32 v50, v20, v21
    v_exp_f32 v23, v23
    s_waitcnt lgkmcnt(5)
    v_mfma_f32_32x32x16_bf16 v[32:47], v[76:79], v[12:15], v[32:47]
    v_exp_f32 v24, v24
    v_cvt_pk_bf16_f32 v51, v22, v23
    v_exp_f32 v25, v25
    v_exp_f32 v26, v26
    v_cvt_pk_bf16_f32 v52, v24, v25
    v_exp_f32 v27, v27
    v_mfma_f32_32x32x16_bf16 v[56:71], v[80:83], v[48:51], v[56:71]
    ds_read_b128 v[80:83], v1 offset:63488
    ds_read_b64_tr_b16 v[240:241], v6 offset:3584
    ds_read_b64_tr_b16 v[242:243], v6 offset:4096
    ds_read_b64_tr_b16 v[244:245], v6 offset:4608
    ds_read_b64_tr_b16 v[246:247], v7 offset:5120
    v_exp_f32 v28, v28
    v_cvt_pk_bf16_f32 v53, v26, v27
    v_exp_f32 v29, v29
    v_exp_f32 v30, v30
    v_exp_f32 v31, v31
    v_cvt_pk_bf16_f32 v54, v28, v29
    v_cvt_pk_bf16_f32 v55, v30, v31
    s_waitcnt lgkmcnt(5)
    v_exp_f32 v32, v32
    v_exp_f32 v33, v33
    v_exp_f32 v34, v34
    v_cvt_pk_bf16_f32 v48, v32, v33
    v_exp_f32 v35, v35
    v_mfma_f32_32x32x16_bf16 v[56:71], v[84:87], v[52:55], v[56:71]
    ds_read_b128 v[84:87], v1 offset:64512
    v_exp_f32 v36, v36
    v_cvt_pk_bf16_f32 v49, v34, v35
    v_exp_f32 v37, v37
    v_exp_f32 v38, v38
    v_cvt_pk_bf16_f32 v50, v36, v37
    v_exp_f32 v39, v39
    s_waitcnt lgkmcnt(5)
    v_exp_f32 v40, v40
    v_cvt_pk_bf16_f32 v51, v38, v39
    v_exp_f32 v41, v41
    v_exp_f32 v42, v42
    v_cvt_pk_bf16_f32 v52, v40, v41
    v_exp_f32 v43, v43
    v_mfma_f32_32x32x16_bf16 v[56:71], v[80:83], v[48:51], v[56:71]
    ds_read_b64_tr_b16 v[248:249], v6 offset:5376
    ds_read_b64_tr_b16 v[250:251], v6 offset:5888
    ds_read_b64_tr_b16 v[252:253], v6 offset:6400
    ds_read_b64_tr_b16 v[254:255], v7 offset:6912
    v_exp_f32 v44, v44
    v_cvt_pk_bf16_f32 v53, v42, v43
    v_exp_f32 v45, v45
    v_exp_f32 v46, v46
    v_exp_f32 v47, v47
    v_cvt_pk_bf16_f32 v54, v44, v45
    v_cvt_pk_bf16_f32 v55, v46, v47
    s_waitcnt lgkmcnt(4)
    s_nop 1
    v_mfma_f32_32x32x16_bf16 v[56:71], v[84:87], v[52:55], v[56:71]
    s_setprio 0
    s_waitcnt vmcnt(0)
    v_sub_f32 v124, 1.0, v125
    s_cmp_eq_u32 s41, 0
    s_cselect_b64 vcc, -1, 0
    v_cndmask_b32 v124, v124, v125, vcc
    s_nop 7
    v_mov_b32 v112, v68
    v_mov_b32 v113, v68
    v_pk_add_f32 v[16:17], v[56:57], v[58:59]
    v_pk_add_f32 v[18:19], v[60:61], v[62:63]
    v_permlane32_swap_b32 v112, v113
    v_pk_add_f32 v[20:21], v[64:65], v[66:67]
    v_pk_add_f32 v[22:23], v[68:69], v[70:71]
    v_rcp_f32 v112, v113
    v_permlane32_swap_b32 v68, v63
    v_permlane32_swap_b32 v69, v71
    v_mul_f32 v112, v112, v124
    v_pk_add_f32 v[16:17], v[16:17], v[18:19]
    v_pk_add_f32 v[20:21], v[20:21], v[22:23]
    s_mov_b32 exec_lo, 0
    v_mov_b32 v70, v63
    s_mov_b32 exec_lo, -1
    v_pk_add_f32 v[16:17], v[16:17], v[20:21]
    s_mov_b32 s51, 0x33800000
    v_cmp_nle_f32 s[62:63], s51, v113
    v_add_f32 v114, v16, v17
    v_pk_mul_f32 v[56:57], v[56:57], v[112:113] op_sel_hi:[1,0]
    v_pk_mul_f32 v[58:59], v[58:59], v[112:113] op_sel_hi:[1,0]
    v_pk_mul_f32 v[60:61], v[60:61], v[112:113] op_sel_hi:[1,0]
    v_pk_mul_f32 v[62:63], v[62:63], v[112:113] op_sel_hi:[1,0]
    s_mov_b32 s51, 0x207
    v_cmp_class_f32 vcc, v114, s51
    v_pk_mul_f32 v[64:65], v[64:65], v[112:113] op_sel_hi:[1,0]
    v_pk_mul_f32 v[66:67], v[66:67], v[112:113] op_sel_hi:[1,0]
    v_pk_mul_f32 v[68:69], v[68:69], v[112:113] op_sel_hi:[1,0]
    v_pk_mul_f32 v[70:71], v[70:71], v[112:113] op_sel_hi:[1,0]
    s_or_b64 vcc, vcc, s[62:63]
    s_mov_b32 s51, 0x71800000
    v_cmp_nge_f32 s[62:63], s51, v113
    v_cvt_pk_bf16_f32 v80, v56, v57
    v_cvt_pk_bf16_f32 v81, v58, v59
    v_cvt_pk_bf16_f32 v82, v60, v61
    v_cvt_pk_bf16_f32 v83, v62, v119
    v_cvt_pk_bf16_f32 v84, v64, v65
    v_cvt_pk_bf16_f32 v85, v66, v67
    v_cvt_pk_bf16_f32 v86, v68, v69
    v_cvt_pk_bf16_f32 v87, v70, v119
    s_or_b64 vcc, vcc, s[62:63]
    s_cmp_lg_u64 vcc, 0
    s_cselect_b32 s51, 1, 0
    s_cmp_eq_u32 s53, 0
    s_cselect_b32 s51, s51, 0
    s_or_b32 s3, s51, s56
    s_cbranch_scc1 k_nost2
    buffer_store_dwordx4 v[80:83], v1, s[32:35], s55 offen sc1
    buffer_store_dwordx4 v[84:87], v1, s[32:35], s55 offen offset:1024 sc1
    s_mov_b32 s56, 1
k_nost:
    v_mov_b32 v3, s51
    s_cmp_eq_u32 s44, s41
    s_cbranch_scc0 k_own1
    s_lshl_b32 s63, s45, 11
    v_add_u32 v126, s63, v2
    ds_write_b128 v126, v[80:83]
    ds_write_b128 v126, v[84:87] offset:1024
k_own1:
    s_lshl_b32 s3, s40, 2
    s_add_u32 s3, s3, 159744
    v_mov_b32 v4, s3
    s_mov_b64 exec, 1
    ds_write_b32 v4, v3
    s_mov_b64 exec, -1
    v_and_b32 v3, 7, v0
    v_lshlrev_b32 v3, 2, v3
    v_add_u32 v4, 159744, v3
    s_waitcnt lgkmcnt(0)
    s_barrier
    ds_read_b32 v4, v4
    s_cmp_lg_u32 s65, 0
    s_cbranch_scc0 k_own2
    ds_read_b128 v[16:19], v2
    ds_read_b128 v[20:23], v2 offset:1024
    ds_read_b128 v[24:27], v2 offset:2048
    ds_read_b128 v[28:31], v2 offset:3072
    ds_read_b128 v[32:35], v2 offset:4096
    ds_read_b128 v[36:39], v2 offset:5120
    ds_read_b128 v[40:43], v2 offset:6144
    ds_read_b128 v[44:47], v2 offset:7168
k_own2:
    v_and_b32 v131, 0xffff, v131
    v_and_b32 v135, 0xffff, v135
    v_and_b32 v139, 0xffff, v139
    v_and_b32 v143, 0xffff, v143
    v_and_b32 v147, 0xffff, v147
    v_and_b32 v151, 0xffff, v151
    v_and_b32 v155, 0xffff, v155
    v_and_b32 v159, 0xffff, v159
    v_and_b32 v163, 0xffff, v163
    v_and_b32 v167, 0xffff, v167
    v_and_b32 v171, 0xffff, v171
    v_and_b32 v175, 0xffff, v175
    v_and_b32 v179, 0xffff, v179
    v_and_b32 v183, 0xffff, v183
    v_and_b32 v187, 0xffff, v187
    v_and_b32 v191, 0xffff, v191
    v_and_b32 v195, 0xffff, v195
    v_and_b32 v199, 0xffff, v199
    v_and_b32 v203, 0xffff, v203
    v_and_b32 v207, 0xffff, v207
    v_and_b32 v211, 0xffff, v211
    v_and_b32 v215, 0xffff, v215
    v_and_b32 v219, 0xffff, v219
    v_and_b32 v223, 0xffff, v223
    v_and_b32 v227, 0xffff, v227
    v_and_b32 v231, 0xffff, v231
    v_and_b32 v235, 0xffff, v235
    v_and_b32 v239, 0xffff, v239
    v_and_b32 v243, 0xffff, v243
    v_and_b32 v247, 0xffff, v247
    v_and_b32 v251, 0xffff, v251
    v_and_b32 v255, 0xffff, v255
    s_waitcnt lgkmcnt(0)
    v_cmp_ne_u32 vcc, 0, v4
    s_cbranch_vccnz k_fallback
    s_lshl_b32 s3, s47, 15
    s_lshl_b32 s51, s46, 11
    s_add_u32 s4, s3, s51
k_tg1:
    s_lshl_b32 s62, s47, 15
    v_add_u32 v115, s62, v1
    s_cmp_lg_u32 s65, 0
    s_cbranch_scc0 k_own3
    s_waitcnt lgkmcnt(0)
    v_mfma_f32_32x32x16_bf16 v[88:103], v[128:131], v[16:19], 0
    v_mfma_f32_32x32x16_bf16 v[88:103], v[132:135], v[20:23], v[88:103]
    v_mfma_f32_32x32x16_bf16 v[88:103], v[136:139], v[24:27], v[88:103]
    v_mfma_f32_32x32x16_bf16 v[88:103], v[140:143], v[28:31], v[88:103]
    v_mfma_f32_32x32x16_bf16 v[88:103], v[144:147], v[32:35], v[88:103]
    v_mfma_f32_32x32x16_bf16 v[88:103], v[148:151], v[36:39], v[88:103]
    v_mfma_f32_32x32x16_bf16 v[88:103], v[152:155], v[40:43], v[88:103]
    v_mfma_f32_32x32x16_bf16 v[88:103], v[156:159], v[44:47], v[88:103]
k_own3:
    s_waitcnt vmcnt(0)
    s_barrier
k_tgw:
    s_cmp_lg_u32 s65, 0
    s_cbranch_scc1 k_ownb
    s_setprio 1
    s_add_u32 m0, s4, 0
    s_add_u32 s52, s4, s57
    s_add_u32 s52, s52, s70
    buffer_load_dwordx4 v1, s[32:35], s52 offen sc1 lds
    buffer_load_dwordx4 v1, s[32:35], s52 offen offset:1024 sc1 lds
k_ownb:
    s_setprio 0
    s_add_u32 m0, s4, 8192
    s_add_u32 s52, s4, s57
    s_add_u32 s52, s52, s71
    buffer_load_dwordx4 v1, s[32:35], s52 offen sc1 lds
    buffer_load_dwordx4 v1, s[32:35], s52 offen offset:1024 sc1 lds
k_tg2:
    s_lshl_b32 s3, s46, 12
    s_add_u32 s3, s3, 65536
    v_add_u32 v3, s3, v1
    v_and_b32 v116, 31, v0
    v_mul_u32_u24 v116, 896, v116
    v_lshrrev_b32 v104, 5, v0
    v_lshl_add_u32 v116, v104, 4, v116
    s_lshl_b32 s3, s42, 1
    s_add_u32 s3, s3, s41
    s_mul_i32 s3, s3, 28672
    s_add_u32 s6, s3, s50
    s_mov_b32 s60, 0xffff
    s_waitcnt vmcnt(2)
    s_barrier
    s_cmp_lg_u32 s65, 0
    s_cbranch_scc1 k_owna
    ds_read_b128 v[16:19], v115
    ds_read_b128 v[20:23], v115 offset:1024
    ds_read_b128 v[24:27], v115 offset:2048
    ds_read_b128 v[28:31], v115 offset:3072
    ds_read_b128 v[32:35], v115 offset:4096
    ds_read_b128 v[36:39], v115 offset:5120
    ds_read_b128 v[40:43], v115 offset:6144
    ds_read_b128 v[44:47], v115 offset:7168
k_owna:
    s_setprio 1
    s_add_u32 m0, s4, 16384
    s_add_u32 s52, s4, s57
    s_add_u32 s52, s52, s72
    buffer_load_dwordx4 v1, s[32:35], s52 offen sc1 lds
    buffer_load_dwordx4 v1, s[32:35], s52 offen offset:1024 sc1 lds
    s_setprio 0
    s_add_u32 m0, s4, 24576
    s_add_u32 s52, s4, s57
    s_add_u32 s52, s52, s73
    buffer_load_dwordx4 v1, s[32:35], s52 offen sc1 lds
    buffer_load_dwordx4 v1, s[32:35], s52 offen offset:1024 sc1 lds
    s_cmp_lg_u32 s65, 0
    s_cbranch_scc1 k_ownc
    s_waitcnt lgkmcnt(0)
    v_mfma_f32_32x32x16_bf16 v[88:103], v[128:131], v[16:19], 0
    v_bitop3_b32 v106, v19, v23, v119 bitop3:0x7e
    v_bitop3_b32 v107, v27, v31, v119 bitop3:0x7e
    v_bitop3_b32 v108, v35, v39, v119 bitop3:0x7e
    v_bitop3_b32 v109, v43, v47, v119 bitop3:0x7e
    v_mfma_f32_32x32x16_bf16 v[88:103], v[132:135], v[20:23], v[88:103]
    v_or3_b32 v106, v106, v107, v108
    v_or_b32 v106, v106, v109
    v_mfma_f32_32x32x16_bf16 v[88:103], v[136:139], v[24:27], v[88:103]
    v_cmp_lt_u32 vcc, s60, v106
k_ownc:
    s_waitcnt vmcnt(4)
    s_barrier
    ds_read_b128 v[48:51], v115 offset:8192
    ds_read_b128 v[52:55], v115 offset:9216
    ds_read_b128 v[56:59], v115 offset:10240
    ds_read_b128 v[60:63], v115 offset:11264
    ds_read_b128 v[64:67], v115 offset:12288
    ds_read_b128 v[68:71], v115 offset:13312
    ds_read_b128 v[72:75], v115 offset:14336
    ds_read_b128 v[76:79], v115 offset:15360
    s_cbranch_scc1 k_ownd
    v_mfma_f32_32x32x16_bf16 v[88:103], v[140:143], v[28:31], v[88:103]
    v_mfma_f32_32x32x16_bf16 v[88:103], v[144:147], v[32:35], v[88:103]
    v_mfma_f32_32x32x16_bf16 v[88:103], v[148:151], v[36:39], v[88:103]
k_ownd:
    s_waitcnt lgkmcnt(0)
    v_bitop3_b32 v106, v51, v55, v119 bitop3:0x7e
    v_bitop3_b32 v107, v59, v63, v119 bitop3:0x7e
    v_bitop3_b32 v108, v67, v71, v119 bitop3:0x7e
    v_bitop3_b32 v109, v75, v79, v119 bitop3:0x7e
    s_cbranch_scc1 k_owns1
    v_mfma_f32_32x32x16_bf16 v[88:103], v[152:155], v[40:43], v[88:103]
k_owns1:
    v_or3_b32 v106, v106, v107, v108
    v_or_b32 v106, v106, v109
    s_cbranch_scc1 k_owns2
    v_mfma_f32_32x32x16_bf16 v[88:103], v[156:159], v[44:47], v[88:103]
k_owns2:
    v_cmp_lt_u32 s[58:59], s60, v106
    s_cbranch_scc1 k_rt0ok
    s_cbranch_vccnz k_rt0
k_rt0ok:
    s_cmp_lg_u64 s[58:59], 0
    s_cbranch_scc1 k_rt1
k_rt1ok:
    v_mfma_f32_32x32x16_bf16 v[88:103], v[160:163], v[48:51], v[88:103]
    v_mfma_f32_32x32x16_bf16 v[88:103], v[164:167], v[52:55], v[88:103]
    s_waitcnt vmcnt(0)
    s_barrier
    ds_read_b128 v[16:19], v115 offset:16384
    ds_read_b128 v[20:23], v115 offset:17408
    v_mfma_f32_32x32x16_bf16 v[88:103], v[168:171], v[56:59], v[88:103]
    ds_read_b128 v[24:27], v115 offset:18432
    ds_read_b128 v[28:31], v115 offset:19456
    v_mfma_f32_32x32x16_bf16 v[88:103], v[172:175], v[60:63], v[88:103]
    ds_read_b128 v[32:35], v115 offset:20480
    ds_read_b128 v[36:39], v115 offset:21504
    v_mfma_f32_32x32x16_bf16 v[88:103], v[176:179], v[64:67], v[88:103]
    ds_read_b128 v[40:43], v115 offset:22528
    ds_read_b128 v[44:47], v115 offset:23552
    v_mfma_f32_32x32x16_bf16 v[88:103], v[180:183], v[68:71], v[88:103]
    s_waitcnt lgkmcnt(0)
    v_bitop3_b32 v106, v19, v23, v119 bitop3:0x7e
    v_bitop3_b32 v107, v27, v31, v119 bitop3:0x7e
    v_bitop3_b32 v108, v35, v39, v119 bitop3:0x7e
    v_bitop3_b32 v109, v43, v47, v119 bitop3:0x7e
    v_mfma_f32_32x32x16_bf16 v[88:103], v[184:187], v[72:75], v[88:103]
    v_or3_b32 v106, v106, v107, v108
    v_or_b32 v106, v106, v109
    v_mfma_f32_32x32x16_bf16 v[88:103], v[188:191], v[76:79], v[88:103]
    v_cmp_lt_u32 vcc, s60, v106
    s_cbranch_vccnz k_rt2
k_rt2ok:
    v_mfma_f32_32x32x16_bf16 v[88:103], v[192:195], v[16:19], v[88:103]
    ds_read_b128 v[48:51], v115 offset:24576
    ds_read_b128 v[52:55], v115 offset:25600
    v_mfma_f32_32x32x16_bf16 v[88:103], v[196:199], v[20:23], v[88:103]
    ds_read_b128 v[56:59], v115 offset:26624
    ds_read_b128 v[60:63], v115 offset:27648
    v_mfma_f32_32x32x16_bf16 v[88:103], v[200:203], v[24:27], v[88:103]
    ds_read_b128 v[64:67], v115 offset:28672
    ds_read_b128 v[68:71], v115 offset:29696
    v_mfma_f32_32x32x16_bf16 v[88:103], v[204:207], v[28:31], v[88:103]
    ds_read_b128 v[72:75], v115 offset:30720
    ds_read_b128 v[76:79], v115 offset:31744
    v_mfma_f32_32x32x16_bf16 v[88:103], v[208:211], v[32:35], v[88:103]
    v_mfma_f32_32x32x16_bf16 v[88:103], v[212:215], v[36:39], v[88:103]
    s_waitcnt lgkmcnt(0)
    v_bitop3_b32 v106, v51, v55, v119 bitop3:0x7e
    v_bitop3_b32 v107, v59, v63, v119 bitop3:0x7e
    v_bitop3_b32 v108, v67, v71, v119 bitop3:0x7e
    v_bitop3_b32 v109, v75, v79, v119 bitop3:0x7e
    v_mfma_f32_32x32x16_bf16 v[88:103], v[216:219], v[40:43], v[88:103]
    v_or3_b32 v106, v106, v107, v108
    v_or_b32 v106, v106, v109
    v_mfma_f32_32x32x16_bf16 v[88:103], v[220:223], v[44:47], v[88:103]
    v_cmp_lt_u32 vcc, s60, v106
    s_cbranch_vccnz k_rt3
k_rt3ok:
    v_mfma_f32_32x32x16_bf16 v[88:103], v[224:227], v[48:51], v[88:103]
    v_mfma_f32_32x32x16_bf16 v[88:103], v[228:231], v[52:55], v[88:103]
    v_mfma_f32_32x32x16_bf16 v[88:103], v[232:235], v[56:59], v[88:103]
    v_mfma_f32_32x32x16_bf16 v[88:103], v[236:239], v[60:63], v[88:103]
    v_mfma_f32_32x32x16_bf16 v[88:103], v[240:243], v[64:67], v[88:103]
    v_mfma_f32_32x32x16_bf16 v[88:103], v[244:247], v[68:71], v[88:103]
    v_mfma_f32_32x32x16_bf16 v[88:103], v[248:251], v[72:75], v[88:103]
    v_mfma_f32_32x32x16_bf16 v[88:103], v[252:255], v[76:79], v[88:103]
    s_cmp_eq_u32 s47, 0
    s_cbranch_scc0 k_tb
    s_nop 7
    s_nop 3
    ds_write_b128 v3, v[88:91]
    ds_write_b128 v3, v[92:95] offset:1024
    ds_write_b128 v3, v[96:99] offset:2048
    ds_write_b128 v3, v[100:103] offset:3072
    s_waitcnt lgkmcnt(0)
    s_barrier
    s_branch k_tj
k_tb:
    s_barrier
    ds_read_b128 v[16:19], v3
    ds_read_b128 v[20:23], v3 offset:1024
    ds_read_b128 v[24:27], v3 offset:2048
    ds_read_b128 v[28:31], v3 offset:3072
    s_nop 5
    s_waitcnt lgkmcnt(2)
    v_pk_add_f32 v[16:17], v[88:89], v[16:17]
    v_pk_add_f32 v[18:19], v[90:91], v[18:19]
    v_pk_add_f32 v[20:21], v[92:93], v[20:21]
    v_pk_add_f32 v[22:23], v[94:95], v[22:23]
    v_cvt_pk_bf16_f32 v32, v16, v17
    v_cvt_pk_bf16_f32 v33, v18, v19
    v_cvt_pk_bf16_f32 v34, v20, v21
    v_cvt_pk_bf16_f32 v35, v22, v23
    s_waitcnt lgkmcnt(0)
    v_pk_add_f32 v[24:25], v[96:97], v[24:25]
    v_pk_add_f32 v[26:27], v[98:99], v[26:27]
    v_permlane32_swap_b32 v32, v34
    v_permlane32_swap_b32 v33, v35
    v_pk_add_f32 v[28:29], v[100:101], v[28:29]
    v_pk_add_f32 v[30:31], v[102:103], v[30:31]
    buffer_store_dwordx4 v[32:35], v116, s[36:39], s6 offen
    v_cvt_pk_bf16_f32 v36, v24, v25
    v_cvt_pk_bf16_f32 v37, v26, v27
    v_cvt_pk_bf16_f32 v38, v28, v29
    v_cvt_pk_bf16_f32 v39, v30, v31
    s_cmp_eq_u32 s40, 7
    s_cbranch_scc1 k_tj
    v_permlane32_swap_b32 v36, v38
    v_permlane32_swap_b32 v37, v39
    buffer_store_dwordx4 v[36:39], v116, s[36:39], s6 offen offset:32
k_tj:
    s_or_b32 s3, s2, s40
    s_cbranch_scc1 k_noseed
    v_mov_b32 v72, s100
    v_mov_b32 v73, s101
    v_mov_b32 v104, 0
    s_mov_b32 s3, 536576
    s_mov_b64 exec, 1
    buffer_store_dwordx2 v[72:73], v104, s[32:35], s3 offen sc1
    s_mov_b64 exec, -1
k_noseed:
    s_branch k_end
k_fallback:
    s_mov_b32 s53, 1
    v_mov_b32 v112, 0xff800000
    s_mov_b32 s51, 0
k_maxloop:
    buffer_load_dwordx4 v[72:75], v1, s[24:27], s51 offen sc1
    buffer_load_dwordx4 v[76:79], v1, s[24:27], s51 offen offset:1024 sc1
    s_waitcnt vmcnt(0)
    v_mfma_f32_32x32x16_bf16 v[16:31], v[72:75], v[8:11], 0
    v_mfma_f32_32x32x16_bf16 v[16:31], v[76:79], v[12:15], v[16:31]
    s_add_u32 s51, s51, 4096
    s_nop 7
    s_nop 3
    v_max3_f32 v112, v16, v17, v112
    v_max3_f32 v112, v18, v19, v112
    v_max3_f32 v112, v20, v21, v112
    v_max3_f32 v112, v22, v23, v112
    v_max3_f32 v112, v24, v25, v112
    v_max3_f32 v112, v26, v27, v112
    v_max3_f32 v112, v28, v29, v112
    v_max3_f32 v112, v30, v31, v112
    s_cmp_lt_u32 s51, 0x40000
    s_cbranch_scc1 k_maxloop
    v_mov_b32 v113, v112
    s_nop 1
    v_permlane32_swap_b32 v112, v113
    s_nop 1
    v_max_f32 v112, v112, v113
    v_sub_f32 v88, 0, v112
    v_sub_f32 v89, 0, v112
    v_sub_f32 v90, 0, v112
    v_sub_f32 v91, 0, v112
    v_sub_f32 v92, 0, v112
    v_sub_f32 v93, 0, v112
    v_sub_f32 v94, 0, v112
    v_sub_f32 v95, 0, v112
    v_sub_f32 v96, 0, v112
    v_sub_f32 v97, 0, v112
    v_sub_f32 v98, 0, v112
    v_sub_f32 v99, 0, v112
    v_sub_f32 v100, 0, v112
    v_sub_f32 v101, 0, v112
    v_sub_f32 v102, 0, v112
    v_sub_f32 v103, 0, v112
    s_barrier
    s_add_u32 m0, s48, 0
    s_xor_b32 s51, s81, 0
    s_nop 0
    buffer_load_dwordx4 v1, s[24:27], s51 offen sc1 lds
    buffer_load_dwordx4 v1, s[24:27], s51 offen offset:1024 sc1 lds
    buffer_load_dwordx4 v1, s[24:27], s51 offen offset:2048 sc1 lds
    buffer_load_dwordx4 v1, s[24:27], s51 offen offset:3072 sc1 lds
    s_branch k_attn
k_nost2:
    s_cmp_eq_u32 s56, 0
    s_cbranch_scc1 k_nost
    buffer_load_dwordx4 v[80:83], v1, s[32:35], s55 offen sc1
    buffer_load_dwordx4 v[84:87], v1, s[32:35], s55 offen offset:1024 sc1
    s_waitcnt vmcnt(0)
    s_branch k_nost
k_rt0:
    s_lshl_b32 s62, s47, 15
    s_add_u32 s62, s62, s57
    s_add_u32 s62, s62, s70
    s_add_u32 s63, s62, 4096
    s_mov_b32 s54, 0
k_rt0a:
    buffer_load_dwordx4 v[16:19], v1, s[32:35], s62 offen sc1
    buffer_load_dwordx4 v[20:23], v1, s[32:35], s62 offen offset:1024 sc1
    buffer_load_dwordx4 v[24:27], v1, s[32:35], s62 offen offset:2048 sc1
    buffer_load_dwordx4 v[28:31], v1, s[32:35], s62 offen offset:3072 sc1
    buffer_load_dwordx4 v[32:35], v1, s[32:35], s63 offen sc1
    buffer_load_dwordx4 v[36:39], v1, s[32:35], s63 offen offset:1024 sc1
    buffer_load_dwordx4 v[40:43], v1, s[32:35], s63 offen offset:2048 sc1
    buffer_load_dwordx4 v[44:47], v1, s[32:35], s63 offen offset:3072 sc1
    s_add_u32 s54, s54, 1
    s_waitcnt vmcnt(0)
    v_bitop3_b32 v106, v19, v23, v119 bitop3:0x7e
    v_bitop3_b32 v107, v27, v31, v119 bitop3:0x7e
    v_bitop3_b32 v108, v35, v39, v119 bitop3:0x7e
    v_bitop3_b32 v109, v43, v47, v119 bitop3:0x7e
    v_or3_b32 v106, v106, v107, v108
    v_or_b32 v106, v106, v109
    v_cmp_lt_u32 vcc, 0xffff, v106
    s_cbranch_vccz k_rt0r
    s_cmp_lt_u32 s54, 3
    s_cbranch_scc1 k_rt0a
k_rt0l:
    buffer_load_dwordx4 v[16:19], v1, s[32:35], s62 offen sc1
    buffer_load_dwordx4 v[20:23], v1, s[32:35], s62 offen offset:1024 sc1
    buffer_load_dwordx4 v[24:27], v1, s[32:35], s62 offen offset:2048 sc1
    buffer_load_dwordx4 v[28:31], v1, s[32:35], s62 offen offset:3072 sc1
    buffer_load_dwordx4 v[32:35], v1, s[32:35], s63 offen sc1
    buffer_load_dwordx4 v[36:39], v1, s[32:35], s63 offen offset:1024 sc1
    buffer_load_dwordx4 v[40:43], v1, s[32:35], s63 offen offset:2048 sc1
    buffer_load_dwordx4 v[44:47], v1, s[32:35], s63 offen offset:3072 sc1
    s_add_u32 s54, s54, 1
    s_waitcnt vmcnt(0)
    v_bitop3_b32 v106, v19, v23, v119 bitop3:0x7e
    v_bitop3_b32 v107, v27, v31, v119 bitop3:0x7e
    v_bitop3_b32 v108, v35, v39, v119 bitop3:0x7e
    v_bitop3_b32 v109, v43, v47, v119 bitop3:0x7e
    v_or3_b32 v106, v106, v107, v108
    v_or_b32 v106, v106, v109
    v_cmp_lt_u32 vcc, 0xffff, v106
    s_cbranch_vccz k_rt0r
    s_cmp_lt_u32 s54, 16384
    s_cbranch_scc1 k_rt0l
    s_branch k_rt0r
k_rt0r:
    v_mfma_f32_32x32x16_bf16 v[88:103], v[128:131], v[16:19], 0
    v_mfma_f32_32x32x16_bf16 v[88:103], v[132:135], v[20:23], v[88:103]
    v_mfma_f32_32x32x16_bf16 v[88:103], v[136:139], v[24:27], v[88:103]
    v_mfma_f32_32x32x16_bf16 v[88:103], v[140:143], v[28:31], v[88:103]
    v_mfma_f32_32x32x16_bf16 v[88:103], v[144:147], v[32:35], v[88:103]
    v_mfma_f32_32x32x16_bf16 v[88:103], v[148:151], v[36:39], v[88:103]
    v_mfma_f32_32x32x16_bf16 v[88:103], v[152:155], v[40:43], v[88:103]
    v_mfma_f32_32x32x16_bf16 v[88:103], v[156:159], v[44:47], v[88:103]
    s_branch k_rt0ok
k_rt1:
    s_lshl_b32 s62, s47, 15
    s_add_u32 s62, s62, s57
    s_add_u32 s62, s62, s71
    s_add_u32 s63, s62, 4096
    s_mov_b32 s54, 0
k_rt1a:
    buffer_load_dwordx4 v[48:51], v1, s[32:35], s62 offen sc1
    buffer_load_dwordx4 v[52:55], v1, s[32:35], s62 offen offset:1024 sc1
    buffer_load_dwordx4 v[56:59], v1, s[32:35], s62 offen offset:2048 sc1
    buffer_load_dwordx4 v[60:63], v1, s[32:35], s62 offen offset:3072 sc1
    buffer_load_dwordx4 v[64:67], v1, s[32:35], s63 offen sc1
    buffer_load_dwordx4 v[68:71], v1, s[32:35], s63 offen offset:1024 sc1
    buffer_load_dwordx4 v[72:75], v1, s[32:35], s63 offen offset:2048 sc1
    buffer_load_dwordx4 v[76:79], v1, s[32:35], s63 offen offset:3072 sc1
    s_add_u32 s54, s54, 1
    s_waitcnt vmcnt(0)
    v_bitop3_b32 v106, v51, v55, v119 bitop3:0x7e
    v_bitop3_b32 v107, v59, v63, v119 bitop3:0x7e
    v_bitop3_b32 v108, v67, v71, v119 bitop3:0x7e
    v_bitop3_b32 v109, v75, v79, v119 bitop3:0x7e
    v_or3_b32 v106, v106, v107, v108
    v_or_b32 v106, v106, v109
    v_cmp_lt_u32 vcc, 0xffff, v106
    s_cbranch_vccz k_rt1ok
    s_cmp_lt_u32 s54, 3
    s_cbranch_scc1 k_rt1a
k_rt1l:
    buffer_load_dwordx4 v[48:51], v1, s[32:35], s62 offen sc1
    buffer_load_dwordx4 v[52:55], v1, s[32:35], s62 offen offset:1024 sc1
    buffer_load_dwordx4 v[56:59], v1, s[32:35], s62 offen offset:2048 sc1
    buffer_load_dwordx4 v[60:63], v1, s[32:35], s62 offen offset:3072 sc1
    buffer_load_dwordx4 v[64:67], v1, s[32:35], s63 offen sc1
    buffer_load_dwordx4 v[68:71], v1, s[32:35], s63 offen offset:1024 sc1
    buffer_load_dwordx4 v[72:75], v1, s[32:35], s63 offen offset:2048 sc1
    buffer_load_dwordx4 v[76:79], v1, s[32:35], s63 offen offset:3072 sc1
    s_add_u32 s54, s54, 1
    s_waitcnt vmcnt(0)
    v_bitop3_b32 v106, v51, v55, v119 bitop3:0x7e
    v_bitop3_b32 v107, v59, v63, v119 bitop3:0x7e
    v_bitop3_b32 v108, v67, v71, v119 bitop3:0x7e
    v_bitop3_b32 v109, v75, v79, v119 bitop3:0x7e
    v_or3_b32 v106, v106, v107, v108
    v_or_b32 v106, v106, v109
    v_cmp_lt_u32 vcc, 0xffff, v106
    s_cbranch_vccz k_rt1ok
    s_cmp_lt_u32 s54, 16384
    s_cbranch_scc1 k_rt1l
    s_branch k_rt1ok
k_rt2:
    s_lshl_b32 s62, s47, 15
    s_add_u32 s62, s62, s57
    s_add_u32 s62, s62, s72
    s_add_u32 s63, s62, 4096
    s_mov_b32 s54, 0
k_rt2a:
    buffer_load_dwordx4 v[16:19], v1, s[32:35], s62 offen sc1
    buffer_load_dwordx4 v[20:23], v1, s[32:35], s62 offen offset:1024 sc1
    buffer_load_dwordx4 v[24:27], v1, s[32:35], s62 offen offset:2048 sc1
    buffer_load_dwordx4 v[28:31], v1, s[32:35], s62 offen offset:3072 sc1
    buffer_load_dwordx4 v[32:35], v1, s[32:35], s63 offen sc1
    buffer_load_dwordx4 v[36:39], v1, s[32:35], s63 offen offset:1024 sc1
    buffer_load_dwordx4 v[40:43], v1, s[32:35], s63 offen offset:2048 sc1
    buffer_load_dwordx4 v[44:47], v1, s[32:35], s63 offen offset:3072 sc1
    s_add_u32 s54, s54, 1
    s_waitcnt vmcnt(0)
    v_bitop3_b32 v106, v19, v23, v119 bitop3:0x7e
    v_bitop3_b32 v107, v27, v31, v119 bitop3:0x7e
    v_bitop3_b32 v108, v35, v39, v119 bitop3:0x7e
    v_bitop3_b32 v109, v43, v47, v119 bitop3:0x7e
    v_or3_b32 v106, v106, v107, v108
    v_or_b32 v106, v106, v109
    v_cmp_lt_u32 vcc, 0xffff, v106
    s_cbranch_vccz k_rt2ok
    s_cmp_lt_u32 s54, 3
    s_cbranch_scc1 k_rt2a
k_rt2l:
    buffer_load_dwordx4 v[16:19], v1, s[32:35], s62 offen sc1
    buffer_load_dwordx4 v[20:23], v1, s[32:35], s62 offen offset:1024 sc1
    buffer_load_dwordx4 v[24:27], v1, s[32:35], s62 offen offset:2048 sc1
    buffer_load_dwordx4 v[28:31], v1, s[32:35], s62 offen offset:3072 sc1
    buffer_load_dwordx4 v[32:35], v1, s[32:35], s63 offen sc1
    buffer_load_dwordx4 v[36:39], v1, s[32:35], s63 offen offset:1024 sc1
    buffer_load_dwordx4 v[40:43], v1, s[32:35], s63 offen offset:2048 sc1
    buffer_load_dwordx4 v[44:47], v1, s[32:35], s63 offen offset:3072 sc1
    s_add_u32 s54, s54, 1
    s_waitcnt vmcnt(0)
    v_bitop3_b32 v106, v19, v23, v119 bitop3:0x7e
    v_bitop3_b32 v107, v27, v31, v119 bitop3:0x7e
    v_bitop3_b32 v108, v35, v39, v119 bitop3:0x7e
    v_bitop3_b32 v109, v43, v47, v119 bitop3:0x7e
    v_or3_b32 v106, v106, v107, v108
    v_or_b32 v106, v106, v109
    v_cmp_lt_u32 vcc, 0xffff, v106
    s_cbranch_vccz k_rt2ok
    s_cmp_lt_u32 s54, 16384
    s_cbranch_scc1 k_rt2l
    s_branch k_rt2ok
k_rt3:
    s_lshl_b32 s62, s47, 15
    s_add_u32 s62, s62, s57
    s_add_u32 s62, s62, s73
    s_add_u32 s63, s62, 4096
    s_mov_b32 s54, 0
k_rt3a:
    buffer_load_dwordx4 v[48:51], v1, s[32:35], s62 offen sc1
    buffer_load_dwordx4 v[52:55], v1, s[32:35], s62 offen offset:1024 sc1
    buffer_load_dwordx4 v[56:59], v1, s[32:35], s62 offen offset:2048 sc1
    buffer_load_dwordx4 v[60:63], v1, s[32:35], s62 offen offset:3072 sc1
    buffer_load_dwordx4 v[64:67], v1, s[32:35], s63 offen sc1
    buffer_load_dwordx4 v[68:71], v1, s[32:35], s63 offen offset:1024 sc1
    buffer_load_dwordx4 v[72:75], v1, s[32:35], s63 offen offset:2048 sc1
    buffer_load_dwordx4 v[76:79], v1, s[32:35], s63 offen offset:3072 sc1
    s_add_u32 s54, s54, 1
    s_waitcnt vmcnt(0)
    v_bitop3_b32 v106, v51, v55, v119 bitop3:0x7e
    v_bitop3_b32 v107, v59, v63, v119 bitop3:0x7e
    v_bitop3_b32 v108, v67, v71, v119 bitop3:0x7e
    v_bitop3_b32 v109, v75, v79, v119 bitop3:0x7e
    v_or3_b32 v106, v106, v107, v108
    v_or_b32 v106, v106, v109
    v_cmp_lt_u32 vcc, 0xffff, v106
    s_cbranch_vccz k_rt3ok
    s_cmp_lt_u32 s54, 3
    s_cbranch_scc1 k_rt3a
k_rt3l:
    buffer_load_dwordx4 v[48:51], v1, s[32:35], s62 offen sc1
    buffer_load_dwordx4 v[52:55], v1, s[32:35], s62 offen offset:1024 sc1
    buffer_load_dwordx4 v[56:59], v1, s[32:35], s62 offen offset:2048 sc1
    buffer_load_dwordx4 v[60:63], v1, s[32:35], s62 offen offset:3072 sc1
    buffer_load_dwordx4 v[64:67], v1, s[32:35], s63 offen sc1
    buffer_load_dwordx4 v[68:71], v1, s[32:35], s63 offen offset:1024 sc1
    buffer_load_dwordx4 v[72:75], v1, s[32:35], s63 offen offset:2048 sc1
    buffer_load_dwordx4 v[76:79], v1, s[32:35], s63 offen offset:3072 sc1
    s_add_u32 s54, s54, 1
    s_waitcnt vmcnt(0)
    v_bitop3_b32 v106, v51, v55, v119 bitop3:0x7e
    v_bitop3_b32 v107, v59, v63, v119 bitop3:0x7e
    v_bitop3_b32 v108, v67, v71, v119 bitop3:0x7e
    v_bitop3_b32 v109, v75, v79, v119 bitop3:0x7e
    v_or3_b32 v106, v106, v107, v108
    v_or_b32 v106, v106, v109
    v_cmp_lt_u32 vcc, 0xffff, v106
    s_cbranch_vccz k_rt3ok
    s_cmp_lt_u32 s54, 16384
    s_cbranch_scc1 k_rt3l
    s_branch k_rt3ok
    .fill 43, 4, 0xbf800000
k_loader:
    s_sub_u32 s87, s40, 4
    s_xor_b32 s52, s61, 1
    s_mul_i32 s51, s52, 28672
    s_add_u32 s60, s60, s51
    s_mul_i32 s51, s87, 7168
    s_add_u32 s60, s60, s51
    s_lshl_b32 s59, s52, 12
    s_lshl_b32 s51, s87, 10
    s_add_u32 s59, s59, s51
    s_add_u32 s59, s59, 71936
    s_and_b32 s51, s40, 1
    s_lshl_b32 s51, s51, 6
    v_xor_b32 v104, s51, v104
    s_mul_i32 s58, s87, 3584
    s_mul_i32 s87, s87, 14336
    s_lshl_b32 s84, s85, 7
    s_add_u32 s84, s84, s60
    s_mul_i32 s85, s85, 57344
    s_add_u32 s85, s85, s87
    s_add_u32 s86, s87, 401408
    s_waitcnt lgkmcnt(0)
    v_add_u32 v3, 0, v0
    v_mul_u32_u24 v4, 4682, v3
    v_lshrrev_b32 v4, 16, v4
    v_mul_u32_u24 v116, 14, v4
    v_sub_u32 v3, v3, v116
    v_lshlrev_b32 v3, 4, v3
    v_and_b32 v116, 8, v4
    v_and_b32 v117, 1, v4
    v_lshl_add_u32 v116, v117, 2, v116
    v_bfe_u32 v117, v4, 1, 2
    v_add_u32 v116, v116, v117
    v_mul_u32_u24 v116, 896, v116
    v_add_u32 v106, v116, v3
    v_add_u32 v3, 64, v0
    v_mul_u32_u24 v4, 4682, v3
    v_lshrrev_b32 v4, 16, v4
    v_mul_u32_u24 v116, 14, v4
    v_sub_u32 v3, v3, v116
    v_lshlrev_b32 v3, 4, v3
    v_and_b32 v116, 8, v4
    v_and_b32 v117, 1, v4
    v_lshl_add_u32 v116, v117, 2, v116
    v_bfe_u32 v117, v4, 1, 2
    v_add_u32 v116, v116, v117
    v_mul_u32_u24 v116, 896, v116
    v_add_u32 v107, v116, v3
    v_subrev_u32 v107, 1024, v107
    s_mul_i32 s3, s43, 224
    s_add_u32 s20, s6, s3
    s_addc_u32 s21, s7, 0
    s_sub_u32 s22, 401408, s3
    s_mov_b32 s23, 0x20000
    s_barrier
    s_add_u32 m0, s59, 0
    s_nop 0
    buffer_load_dwordx4 v104, s[16:19], s84 offen lds
    s_add_u32 m0, s58, 0
    s_mov_b32 s62, s85
    buffer_load_dwordx4 v106, s[20:23], s62 offen lds
    s_mov_b32 exec_hi, 0xffff
    buffer_load_dwordx4 v107, s[20:23], s62 offen offset:1024 lds
    s_mov_b32 exec_hi, -1
    s_add_u32 m0, s58, 1792
    s_add_u32 s62, s85, 7168
    buffer_load_dwordx4 v106, s[20:23], s62 offen lds
    s_mov_b32 exec_hi, 0xffff
    buffer_load_dwordx4 v107, s[20:23], s62 offen offset:1024 lds
    s_mov_b32 exec_hi, -1
    s_mov_b32 s32, s14
    s_mov_b32 s33, s15
    s_mov_b32 s34, 5242880
    s_mov_b32 s35, 0x20000
    s_lshl_b32 s3, s41, 18
    s_add_u32 s24, s14, s3
    s_addc_u32 s25, s15, 0
    s_mov_b32 s26, 0x40000
    s_mov_b32 s27, 0x20000
    s_and_b32 s44, s40, 1
    s_lshr_b32 s45, s40, 1
    s_and_b32 s46, s40, 3
    s_lshr_b32 s47, s40, 2
    s_cmp_eq_u32 s47, 0
    s_cselect_b32 s28, s8, s10
    s_cselect_b32 s29, s9, s11
    s_mov_b32 s30, 401408
    s_mov_b32 s31, 0x20000
    s_mov_b32 s36, s12
    s_mov_b32 s37, s13
    s_mov_b32 s38, 1835008
    s_mov_b32 s39, 0x20000
    s_lshl_b32 s48, s40, 12
    s_mul_i32 s50, s43, 224
    s_lshl_b32 s3, s46, 6
    s_add_u32 s50, s50, s3
    s_mov_b32 s53, 0
    v_lshrrev_b32 v3, 5, v0
    v_and_b32 v116, 31, v0
    v_bfe_u32 v117, v0, 1, 3
    v_xor_b32 v117, v117, v3
    v_lshlrev_b32 v117, 4, v117
    v_lshl_add_u32 v121, v116, 7, v117
    s_lshl_b32 s3, s44, 12
    s_add_u32 s3, s3, 71936
    v_add_u32 v112, s3, v121
    v_xor_b32 v113, 32, v112
    v_xor_b32 v114, 64, v112
    s_add_u32 s84, s84, 128
    s_add_u32 s85, s85, 57344
    s_cmp_eq_u32 s85, s86
    s_cselect_b32 s85, s87, s85
    s_cselect_b32 s84, s60, s84
    s_add_u32 m0, s59, 8192
    s_nop 0
    buffer_load_dwordx4 v104, s[16:19], s84 offen lds
    s_add_u32 m0, s58, 14336
    s_mov_b32 s62, s85
    buffer_load_dwordx4 v106, s[20:23], s62 offen lds
    s_mov_b32 exec_hi, 0xffff
    buffer_load_dwordx4 v107, s[20:23], s62 offen offset:1024 lds
    s_mov_b32 exec_hi, -1
    s_add_u32 m0, s58, 16128
    s_add_u32 s62, s85, 7168
    buffer_load_dwordx4 v106, s[20:23], s62 offen lds
    s_mov_b32 exec_hi, 0xffff
    buffer_load_dwordx4 v107, s[20:23], s62 offen offset:1024 lds
    s_mov_b32 exec_hi, -1
    v_xor_b32 v115, 96, v112
    v_bfe_u32 v4, v0, 4, 1
    v_lshlrev_b32 v4, 5, v4
    v_and_b32 v116, 3, v0
    v_lshl_add_u32 v4, v116, 3, v4
    v_bfe_u32 v116, v0, 2, 2
    v_lshlrev_b32 v117, 1, v116
    v_lshl_add_u32 v117, v3, 3, v117
    v_mul_u32_u24 v108, 224, v117
    v_add_u32 v108, v108, v4
    s_mul_i32 s3, s45, 56
    v_add_u32 v108, s3, v108
    v_add_u32 v109, 57344, v108
    v_add_u32 v110, 129280, v108
    s_mul_i32 s49, s40, 7168
    s_add_u32 s49, s49, 98304
    v_lshl_add_u32 v7, v116, 6, v4
    v_add_u32 v7, s49, v7
    v_lshl_add_u32 v6, v3, 8, v7
    v_lshrrev_b32 v3, 2, v0
    v_mul_u32_u24 v3, 896, v3
    v_and_b32 v4, 3, v0
    v_lshl_add_u32 v111, v4, 4, v3
    s_mul_i32 s5, s41, 16384
    s_add_u32 s5, s5, 557056
    s_lshl_b32 s3, s42, 2
    s_add_u32 s51, s3, s43
    s_lshl_b32 s51, s51, 3
    s_add_u32 s4, s51, s5
    s_lshr_b32 s3, s3, 1
    s_add_u32 s3, s3, s61
    s_lshl_b32 s3, s3, 12
    s_lshl_b32 s51, s41, 18
    s_add_u32 s84, s84, 128
    s_add_u32 s85, s85, 57344
    s_cmp_eq_u32 s85, s86
    s_cselect_b32 s85, s87, s85
    s_cselect_b32 s84, s60, s84
    s_add_u32 m0, s59, 16384
    s_nop 0
    buffer_load_dwordx4 v104, s[16:19], s84 offen lds
    s_add_u32 m0, s58, 28672
    s_mov_b32 s62, s85
    buffer_load_dwordx4 v106, s[20:23], s62 offen lds
    s_mov_b32 exec_hi, 0xffff
    buffer_load_dwordx4 v107, s[20:23], s62 offen offset:1024 lds
    s_mov_b32 exec_hi, -1
    s_add_u32 m0, s58, 30464
    s_add_u32 s62, s85, 7168
    buffer_load_dwordx4 v106, s[20:23], s62 offen lds
    s_mov_b32 exec_hi, 0xffff
    buffer_load_dwordx4 v107, s[20:23], s62 offen offset:1024 lds
    s_mov_b32 exec_hi, -1
    s_add_u32 s3, s3, s51
    s_lshr_b32 s51, s43, 1
    s_lshl_b32 s51, s51, 11
    s_add_u32 s82, s3, s51
    s_and_b32 s3, s2, 7
    s_lshl_b32 s3, s3, 1
    s_lshr_b32 s51, s2, 7
    s_add_u32 s3, s3, s51
    s_lshl_b32 s3, s3, 10
    s_branch k_pv5_over
k_pv5:
    s_branch k_setup
k_pv5_over:
    s_add_u32 s5, s5, s3
    s_lshr_b32 s3, s42, 2
    s_and_b32 s3, s3, 7
    s_lshl_b32 s81, s3, 15
    s_add_u32 s81, s81, s48
    s_lshl_b32 s3, s3, 7
    v_xor_b32 v5, s3, v1
    s_lshl_b32 s3, s42, 1
    s_add_u32 s83, s3, s61
    s_lshl_b32 s83, s83, 7
    s_add_u32 s83, s83, 524288
    s_add_u32 s3, s3, s44
    s_lshl_b32 s3, s3, 1
    s_add_u32 s3, s3, s41
    s_lshl_b32 s3, s3, 15
    s_lshl_b32 s51, s43, 2
    s_add_u32 s51, s51, s45
    s_lshl_b32 s51, s51, 11
    s_add_u32 s3, s3, s51
    s_add_u32 s55, s3, 1048576
    s_mov_b32 s56, 0
    s_lshl_b32 s3, s42, 1
    s_add_u32 s3, s3, s41
    s_lshl_b32 s3, s3, 16
    s_add_u32 s57, s3, 1048576
    v_add_u32 v2, 0x10000, v1
    v_mov_b32 v88, 0
    s_add_u32 s84, s84, 128
    s_add_u32 s85, s85, 57344
    s_cmp_eq_u32 s85, s86
    s_cselect_b32 s85, s87, s85
    s_cselect_b32 s84, s60, s84
    s_add_u32 m0, s59, 24576
    s_nop 0
    buffer_load_dwordx4 v104, s[16:19], s84 offen lds
    s_add_u32 m0, s58, 43008
    s_mov_b32 s62, s85
    buffer_load_dwordx4 v106, s[20:23], s62 offen lds
    s_mov_b32 exec_hi, 0xffff
    buffer_load_dwordx4 v107, s[20:23], s62 offen offset:1024 lds
    s_mov_b32 exec_hi, -1
    s_add_u32 m0, s58, 44800
    s_add_u32 s62, s85, 7168
    buffer_load_dwordx4 v106, s[20:23], s62 offen lds
    s_mov_b32 exec_hi, 0xffff
    buffer_load_dwordx4 v107, s[20:23], s62 offen offset:1024 lds
    s_mov_b32 exec_hi, -1
    v_mov_b32 v89, 0
    v_mov_b32 v90, 0
    v_mov_b32 v91, 0
    v_mov_b32 v92, 0
    v_mov_b32 v93, 0
    v_mov_b32 v94, 0
    v_mov_b32 v95, 0
    v_mov_b32 v96, 0
    v_mov_b32 v97, 0
    v_mov_b32 v98, 0
    v_mov_b32 v99, 0
    v_mov_b32 v100, 0
    v_mov_b32 v101, 0
    v_mov_b32 v102, 0
    v_mov_b32 v103, 0
    s_cmp_eq_u32 s47, s41
    s_cselect_b32 s65, 1, 0
    s_cselect_b32 s3, s43, 0
    s_lshl_b32 s3, s3, 3
    s_lshr_b32 s64, 0x9372b19c, s3
    s_sub_u32 s74, s50, 256
    s_and_b32 s3, s64, 3
    s_lshl_b32 s70, s3, 13
    s_mul_i32 s3, s3, 100352
    s_add_u32 s66, s3, s74
    s_add_u32 s75, s3, s50
    s_bfe_u32 s3, s64, 0x20002
    s_lshl_b32 s71, s3, 13
    s_mul_i32 s3, s3, 100352
    s_add_u32 s67, s3, s74
    s_bfe_u32 s3, s64, 0x20004
    s_lshl_b32 s72, s3, 13
    s_mul_i32 s3, s3, 100352
    s_add_u32 s68, s3, s74
    s_bfe_u32 s3, s64, 0x20006
    s_lshl_b32 s73, s3, 13
    s_mul_i32 s3, s3, 100352
    s_add_u32 s69, s3, s74
    s_waitcnt vmcnt(10)
    s_setprio 0
    s_barrier
    s_add_u32 s84, s84, 128
    s_add_u32 s85, s85, 57344
    s_cmp_eq_u32 s85, s86
    s_cselect_b32 s85, s87, s85
    s_cselect_b32 s84, s60, s84
    s_add_u32 m0, s59, 32768
    s_nop 0
    buffer_load_dwordx4 v104, s[16:19], s84 offen lds
    s_add_u32 m0, s58, 57344
    s_mov_b32 s62, s85
    buffer_load_dwordx4 v106, s[20:23], s62 offen lds
    s_mov_b32 exec_hi, 0xffff
    buffer_load_dwordx4 v107, s[20:23], s62 offen offset:1024 lds
    s_mov_b32 exec_hi, -1
    s_add_u32 m0, s58, 59136
    s_add_u32 s62, s85, 7168
    buffer_load_dwordx4 v106, s[20:23], s62 offen lds
    s_mov_b32 exec_hi, 0xffff
    buffer_load_dwordx4 v107, s[20:23], s62 offen offset:1024 lds
    s_mov_b32 exec_hi, -1
    s_add_u32 s84, s84, 128
    s_add_u32 s85, s85, 57344
    s_cmp_eq_u32 s85, s86
    s_cselect_b32 s85, s87, s85
    s_cselect_b32 s84, s60, s84
    s_add_u32 m0, s59, 40960
    s_nop 0
    buffer_load_dwordx4 v104, s[16:19], s84 offen lds
    s_add_u32 m0, s58, 129280
    s_mov_b32 s62, s85
    buffer_load_dwordx4 v106, s[20:23], s62 offen lds
    s_mov_b32 exec_hi, 0xffff
    buffer_load_dwordx4 v107, s[20:23], s62 offen offset:1024 lds
    s_mov_b32 exec_hi, -1
    s_add_u32 m0, s58, 131072
    s_add_u32 s62, s85, 7168
    buffer_load_dwordx4 v106, s[20:23], s62 offen lds
    s_mov_b32 exec_hi, 0xffff
    buffer_load_dwordx4 v107, s[20:23], s62 offen offset:1024 lds
    s_mov_b32 exec_hi, -1
    s_add_u32 s84, s84, 128
    s_add_u32 s85, s85, 57344
    s_cmp_eq_u32 s85, s86
    s_cselect_b32 s85, s87, s85
    s_cselect_b32 s84, s60, s84
    s_add_u32 m0, s59, 49152
    s_nop 0
    buffer_load_dwordx4 v104, s[16:19], s84 offen lds
    s_add_u32 m0, s58, 143616
    s_mov_b32 s62, s85
    buffer_load_dwordx4 v106, s[20:23], s62 offen lds
    s_mov_b32 exec_hi, 0xffff
    buffer_load_dwordx4 v107, s[20:23], s62 offen offset:1024 lds
    s_mov_b32 exec_hi, -1
    s_add_u32 m0, s58, 145408
    s_add_u32 s62, s85, 7168
    buffer_load_dwordx4 v106, s[20:23], s62 offen lds
    s_mov_b32 exec_hi, 0xffff
    buffer_load_dwordx4 v107, s[20:23], s62 offen offset:1024 lds
    s_mov_b32 exec_hi, -1
    s_waitcnt vmcnt(10)
    s_barrier
    s_setprio 3
    ds_read_b64_tr_b16 v[128:129], v108
    ds_read_b64_tr_b16 v[130:131], v108 offset:224
    ds_read_b128 v[144:147], v112
    ds_read_b64_tr_b16 v[132:133], v108 offset:3584
    ds_read_b64_tr_b16 v[134:135], v108 offset:3808
    ds_read_b128 v[148:151], v113
    ds_read_b64_tr_b16 v[136:137], v108 offset:7168
    ds_read_b64_tr_b16 v[138:139], v108 offset:7392
    ds_read_b128 v[152:155], v114
    ds_read_b64_tr_b16 v[140:141], v108 offset:10752
    ds_read_b64_tr_b16 v[142:143], v108 offset:10976
    ds_read_b128 v[156:159], v115
    s_waitcnt lgkmcnt(0)
    v_mfma_f32_32x32x16_bf16 v[16:31], v[128:131], v[144:147], 0
    ds_read_b64_tr_b16 v[160:161], v108 offset:14336
    ds_read_b64_tr_b16 v[162:163], v108 offset:14560
    ds_read_b128 v[176:179], v112 offset:8192
    v_mfma_f32_32x32x16_bf16 v[16:31], v[132:135], v[148:151], v[16:31]
    ds_read_b64_tr_b16 v[164:165], v108 offset:17920
    ds_read_b64_tr_b16 v[166:167], v108 offset:18144
    ds_read_b128 v[180:183], v113 offset:8192
    v_mfma_f32_32x32x16_bf16 v[16:31], v[136:139], v[152:155], v[16:31]
    ds_read_b64_tr_b16 v[168:169], v108 offset:21504
    ds_read_b64_tr_b16 v[170:171], v108 offset:21728
    ds_read_b128 v[184:187], v114 offset:8192
    v_mfma_f32_32x32x16_bf16 v[16:31], v[140:143], v[156:159], v[16:31]
    ds_read_b64_tr_b16 v[172:173], v108 offset:25088
    ds_read_b64_tr_b16 v[174:175], v108 offset:25312
    ds_read_b128 v[188:191], v115 offset:8192
    s_waitcnt lgkmcnt(0)
    v_mfma_f32_32x32x16_bf16 v[16:31], v[160:163], v[176:179], v[16:31]
    ds_read_b64_tr_b16 v[128:129], v108 offset:28672
    ds_read_b64_tr_b16 v[130:131], v108 offset:28896
    ds_read_b128 v[144:147], v112 offset:16384
    v_mfma_f32_32x32x16_bf16 v[16:31], v[164:167], v[180:183], v[16:31]
    ds_read_b64_tr_b16 v[132:133], v108 offset:32256
    ds_read_b64_tr_b16 v[134:135], v108 offset:32480
    ds_read_b128 v[148:151], v113 offset:16384
    v_mfma_f32_32x32x16_bf16 v[16:31], v[168:171], v[184:187], v[16:31]
    ds_read_b64_tr_b16 v[136:137], v108 offset:35840
    ds_read_b64_tr_b16 v[138:139], v108 offset:36064
    ds_read_b128 v[152:155], v114 offset:16384
    v_mfma_f32_32x32x16_bf16 v[16:31], v[172:175], v[188:191], v[16:31]
    ds_read_b64_tr_b16 v[140:141], v108 offset:39424
    ds_read_b64_tr_b16 v[142:143], v108 offset:39648
    ds_read_b128 v[156:159], v115 offset:16384
    s_waitcnt lgkmcnt(0)
    v_mfma_f32_32x32x16_bf16 v[16:31], v[128:131], v[144:147], v[16:31]
    ds_read_b64_tr_b16 v[160:161], v108 offset:43008
    ds_read_b64_tr_b16 v[162:163], v108 offset:43232
    ds_read_b128 v[176:179], v112 offset:24576
    v_mfma_f32_32x32x16_bf16 v[16:31], v[132:135], v[148:151], v[16:31]
    ds_read_b64_tr_b16 v[164:165], v108 offset:46592
    ds_read_b64_tr_b16 v[166:167], v108 offset:46816
    ds_read_b128 v[180:183], v113 offset:24576
    v_mfma_f32_32x32x16_bf16 v[16:31], v[136:139], v[152:155], v[16:31]
    ds_read_b64_tr_b16 v[168:169], v108 offset:50176
    ds_read_b64_tr_b16 v[170:171], v108 offset:50400
    ds_read_b128 v[184:187], v114 offset:24576
    v_mfma_f32_32x32x16_bf16 v[16:31], v[140:143], v[156:159], v[16:31]
    ds_read_b64_tr_b16 v[172:173], v108 offset:53760
    ds_read_b64_tr_b16 v[174:175], v108 offset:53984
    ds_read_b128 v[188:191], v115 offset:24576
    s_waitcnt lgkmcnt(0)
    v_mfma_f32_32x32x16_bf16 v[16:31], v[160:163], v[176:179], v[16:31]
    ds_read_b64_tr_b16 v[128:129], v109
    ds_read_b64_tr_b16 v[130:131], v109 offset:224
    ds_read_b128 v[144:147], v112 offset:32768
    v_mfma_f32_32x32x16_bf16 v[16:31], v[164:167], v[180:183], v[16:31]
    ds_read_b64_tr_b16 v[132:133], v109 offset:3584
    ds_read_b64_tr_b16 v[134:135], v109 offset:3808
    ds_read_b128 v[148:151], v113 offset:32768
    v_mfma_f32_32x32x16_bf16 v[16:31], v[168:171], v[184:187], v[16:31]
    ds_read_b64_tr_b16 v[136:137], v109 offset:7168
    ds_read_b64_tr_b16 v[138:139], v109 offset:7392
    ds_read_b128 v[152:155], v114 offset:32768
    v_mfma_f32_32x32x16_bf16 v[16:31], v[172:175], v[188:191], v[16:31]
    ds_read_b64_tr_b16 v[140:141], v109 offset:10752
    ds_read_b64_tr_b16 v[142:143], v109 offset:10976
    ds_read_b128 v[156:159], v115 offset:32768
    s_setprio 0
    s_waitcnt vmcnt(0)
    s_barrier
    s_waitcnt lgkmcnt(0)
    v_mfma_f32_32x32x16_bf16 v[16:31], v[128:131], v[144:147], v[16:31]
    ds_read_b64_tr_b16 v[160:161], v110
    ds_read_b64_tr_b16 v[162:163], v110 offset:224
    ds_read_b128 v[176:179], v112 offset:40960
    v_mfma_f32_32x32x16_bf16 v[16:31], v[132:135], v[148:151], v[16:31]
    ds_read_b64_tr_b16 v[164:165], v110 offset:3584
    ds_read_b64_tr_b16 v[166:167], v110 offset:3808
    ds_read_b128 v[180:183], v113 offset:40960
    v_mfma_f32_32x32x16_bf16 v[16:31], v[136:139], v[152:155], v[16:31]
    ds_read_b64_tr_b16 v[168:169], v110 offset:7168
    ds_read_b64_tr_b16 v[170:171], v110 offset:7392
    ds_read_b128 v[184:187], v114 offset:40960
    v_mfma_f32_32x32x16_bf16 v[16:31], v[140:143], v[156:159], v[16:31]
    ds_read_b64_tr_b16 v[172:173], v110 offset:10752
    ds_read_b64_tr_b16 v[174:175], v110 offset:10976
    ds_read_b128 v[188:191], v115 offset:40960
    s_setprio 0
    s_waitcnt lgkmcnt(0)
    s_barrier
    s_add_u32 m0, s48, 0
    s_xor_b32 s51, s81, 0
    s_nop 0
    buffer_load_dwordx4 v1, s[24:27], s51 offen sc1 lds
    buffer_load_dwordx4 v1, s[24:27], s51 offen offset:1024 sc1 lds
    buffer_load_dwordx4 v1, s[24:27], s51 offen offset:2048 sc1 lds
    buffer_load_dwordx4 v1, s[24:27], s51 offen offset:3072 sc1 lds
    v_mfma_f32_32x32x16_bf16 v[16:31], v[160:163], v[176:179], v[16:31]
    ds_read_b64_tr_b16 v[128:129], v110 offset:14336
    ds_read_b64_tr_b16 v[130:131], v110 offset:14560
    ds_read_b128 v[144:147], v112 offset:49152
    v_mfma_f32_32x32x16_bf16 v[16:31], v[164:167], v[180:183], v[16:31]
    ds_read_b64_tr_b16 v[132:133], v110 offset:17920
    ds_read_b64_tr_b16 v[134:135], v110 offset:18144
    ds_read_b128 v[148:151], v113 offset:49152
    v_mfma_f32_32x32x16_bf16 v[16:31], v[168:171], v[184:187], v[16:31]
    ds_read_b64_tr_b16 v[136:137], v110 offset:21504
    ds_read_b64_tr_b16 v[138:139], v110 offset:21728
    ds_read_b128 v[152:155], v114 offset:49152
    v_mfma_f32_32x32x16_bf16 v[16:31], v[172:175], v[188:191], v[16:31]
    ds_read_b64_tr_b16 v[140:141], v110 offset:25088
    ds_read_b64_tr_b16 v[142:143], v110 offset:25312
    ds_read_b128 v[156:159], v115 offset:49152
    s_branch k_qt
k_end:
    s_endpgm
.section .rodata,"a"
.p2align 6
.amdhsa_kernel gated_mix__grouped_kv_mqa__grouped_kv_mqa__prompt_kernel
  .amdhsa_next_free_vgpr 256
  .amdhsa_next_free_sgpr 102
  .amdhsa_accum_offset 256
  .amdhsa_group_segment_fixed_size 0
  .amdhsa_kernarg_size 112
  .amdhsa_user_sgpr_count 2
  .amdhsa_user_sgpr_kernarg_segment_ptr 1
  .amdhsa_system_sgpr_workgroup_id_x 1
.end_amdhsa_kernel
```
